```python
import torch

def _softmax(x, axis=-1):
    return torch.softmax(x, dim=axis)
def _gelu(x):
    return torch.nn.functional.gelu(x, approximate="tanh")
def _silu(x):
    return torch.nn.functional.silu(x)
def _sigmoid(x):
    return torch.sigmoid(x)
def _layernorm(x, axis=-1, eps=1e-5):
    m = x.mean(dim=axis, keepdim=True)
    v = x.var(dim=axis, keepdim=True, unbiased=False)
    return (x - m) / torch.sqrt(v + eps)
def _scatter_add(tgt, idx, src, axis=0):
    return tgt.clone().index_add_(axis, idx, src)
def _segment_sum(src, seg, n):
    out = torch.zeros((n,) + src.shape[1:], dtype=src.dtype)
    return out.index_add_(0, seg, src)
def _pad(x, pw):
    flat = tuple(v for pair in reversed(pw) for v in pair)
    return torch.nn.functional.pad(x, flat)

kernel_name = 'gather_scatter__edge_featured_mpnn_egc__graph'

def setup_inputs():

    _w = (lambda a: (lambda t: t.to(torch.bfloat16) if t.is_floating_point() else t)(torch.as_tensor(a)))
    N, deg, D, De = 10000, 32, 128, max(16, 1)
    E = N * deg
    return {
        "x": _w((lambda *s: torch.randn(*s, dtype=torch.bfloat16) * 0.2)(N, D)),
        "e_attr": _w((lambda *s: torch.randn(*s, dtype=torch.bfloat16) * 0.2)(E, De)),
        "src": _w((lambda lo, hi, *s: torch.randint(lo, hi, s))(0, N, E).to(torch.int64)),
        "dst": _w((lambda lo, hi, *s: torch.randint(lo, hi, s))(0, N, E).to(torch.int64)),
        "u_w": _w((lambda *s: torch.randn(*s, dtype=torch.bfloat16) * 0.05)(D, D)),
        "v_w": _w((lambda *s: torch.randn(*s, dtype=torch.bfloat16) * 0.05)(D, D)),
        "g_w": _w((lambda *s: torch.randn(*s, dtype=torch.bfloat16) * 0.2)(2 * D + De, D)),
    }

def reference(x, e_attr, src, dst, u_w, v_w, g_w):
    N, D = x.shape
    g_in = torch.concatenate([x[dst], x[src], e_attr], axis=-1)
    eta = _sigmoid(g_in @ g_w)
    hv = x @ v_w
    msg = eta * hv[src]
    agg = _segment_sum(msg, dst, N)
    return _silu(x @ u_w + agg)
```

```asm
; @launch kernel=egc_prep_kernel grid=(288,1,1) block=(512,1,1) lds=36864
; @launch kernel=egc_main_kernel grid=(250,1,1) block=(1024,1,1) lds=156032
.amdgcn_target "amdgcn-amd-amdhsa--gfx950"
.text
.globl egc_prep_kernel
.p2align 8
.type egc_prep_kernel,@function
egc_prep_kernel:
    s_cmp_ge_u32 s2, 288
    s_cbranch_scc1 K1_EXIT
    s_load_dwordx4 s[4:7], s[0:1], 0
    s_load_dwordx4 s[8:11], s[0:1], 16
    s_load_dwordx4 s[12:15], s[0:1], 32
    s_load_dwordx2 s[16:17], s[0:1], 48
    s_load_dwordx2 s[18:19], s[0:1], 72
    s_add_u32 s20, s2, 158
    s_sub_u32 s21, s2, 125
    s_cmp_lt_u32 s2, 125
    s_cselect_b32 s22, s20, s21
    s_cmp_lt_u32 s2, 283
    s_cselect_b32 s2, s22, s2
    s_waitcnt lgkmcnt(0)
    s_cmp_lt_u32 s2, 158
    s_cbranch_scc1 K1_TABLE
    s_cmp_lt_u32 s2, 283
    s_cbranch_scc1 K1_BIN
    s_cmp_lt_u32 s2, 287
    s_cbranch_scc1 K1_WF
    s_branch K1_CF
K1_EXIT:
    s_endpgm
K1_TABLE:
    s_and_b32 s3, s2, 1
    s_lshr_b32 s28, s2, 1
    s_mov_b32 s20, s16
    s_and_b32 s21, s17, 0xffff
    s_mov_b32 s22, 69632
    s_mov_b32 s23, 0x00020000
    s_mov_b32 s36, s14
    s_and_b32 s37, s15, 0xffff
    s_mov_b32 s38, 32768
    s_mov_b32 s39, 0x00020000
    s_mov_b32 s24, s4
    s_and_b32 s25, s5, 0xffff
    s_mov_b32 s26, 2560000
    s_mov_b32 s27, 0x00020000
    s_lshl_b32 s29, s3, 7
    s_add_u32 s30, s29, 32768
    v_lshrrev_b32 v1, 3, v0
    v_and_b32 v2, 7, v0
    v_lshlrev_b32 v3, 8, v1
    v_lshl_add_u32 v3, v2, 4, v3
    buffer_load_dwordx4 v[8:11], v3, s[20:23], s30 offen
    s_add_u32 s30, s30, 16384
    buffer_load_dwordx4 v[12:15], v3, s[20:23], s30 offen
    buffer_load_dwordx4 v[16:19], v3, s[36:39], s29 offen
    s_add_u32 s29, s29, 16384
    buffer_load_dwordx4 v[20:23], v3, s[36:39], s29 offen
    v_mul_u32_u24 v7, 288, v1
    v_lshl_add_u32 v7, v2, 4, v7
    v_and_b32 v2, 15, v0
    v_bfe_u32 v3, v0, 4, 2
    v_lshrrev_b32 v4, 6, v0
    s_lshl_b32 s31, s28, 7
    v_lshl_add_u32 v5, v4, 4, s31
    v_add_u32 v6, v5, v2
    v_lshlrev_b32 v6, 8, v6
    v_lshl_add_u32 v6, v3, 4, v6
    buffer_load_dwordx4 v[40:43], v6, s[24:27], 0 offen offset:0
    buffer_load_dwordx4 v[44:47], v6, s[24:27], 0 offen offset:64
    buffer_load_dwordx4 v[48:51], v6, s[24:27], 0 offen offset:128
    buffer_load_dwordx4 v[52:55], v6, s[24:27], 0 offen offset:192
    s_mov_b32 s32, s18
    s_and_b32 s33, s19, 0xffff
    s_mov_b32 s34, 5120512
    s_mov_b32 s35, 0x00020000
    s_waitcnt vmcnt(7)
    ds_write_b128 v7, v[8:11] offset:0
    s_waitcnt vmcnt(6)
    ds_write_b128 v7, v[12:15] offset:18432
    s_waitcnt vmcnt(5)
    ds_write_b128 v7, v[16:19] offset:128
    s_waitcnt vmcnt(4)
    ds_write_b128 v7, v[20:23] offset:18560
    v_lshrrev_b32 v7, 2, v2
    v_lshl_add_u32 v7, v3, 3, v7
    v_mul_u32_u24 v7, 288, v7
    v_and_b32 v1, 3, v0
    v_lshl_add_u32 v7, v1, 3, v7
    v_lshl_add_u32 v1, v3, 2, v5
    v_lshlrev_b32 v6, 8, v1
    v_lshl_add_u32 v6, v2, 4, v6
    s_mul_i32 s3, s3, 2560256
    s_waitcnt lgkmcnt(0)
    s_barrier
    ds_read_b64_tr_b16 v[8:9], v7 offset:0
    ds_read_b64_tr_b16 v[10:11], v7 offset:1152
    ds_read_b64_tr_b16 v[12:13], v7 offset:9216
    ds_read_b64_tr_b16 v[14:15], v7 offset:10368
    ds_read_b64_tr_b16 v[16:17], v7 offset:18432
    ds_read_b64_tr_b16 v[18:19], v7 offset:19584
    ds_read_b64_tr_b16 v[20:21], v7 offset:27648
    ds_read_b64_tr_b16 v[22:23], v7 offset:28800
    s_waitcnt vmcnt(0)
    ds_read_b64_tr_b16 v[24:25], v7 offset:32
    ds_read_b64_tr_b16 v[26:27], v7 offset:1184
    ds_read_b64_tr_b16 v[28:29], v7 offset:9248
    ds_read_b64_tr_b16 v[30:31], v7 offset:10400
    ds_read_b64_tr_b16 v[32:33], v7 offset:18464
    ds_read_b64_tr_b16 v[34:35], v7 offset:19616
    ds_read_b64_tr_b16 v[36:37], v7 offset:27680
    ds_read_b64_tr_b16 v[38:39], v7 offset:28832
    s_waitcnt lgkmcnt(8)
    v_mfma_f32_16x16x32_bf16 v[64:67], v[40:43], v[8:11], 0
    v_mfma_f32_16x16x32_bf16 v[64:67], v[44:47], v[12:15], v[64:67]
    v_mfma_f32_16x16x32_bf16 v[64:67], v[48:51], v[16:19], v[64:67]
    v_mfma_f32_16x16x32_bf16 v[64:67], v[52:55], v[20:23], v[64:67]
    ds_read_b64_tr_b16 v[96:97], v7 offset:64
    ds_read_b64_tr_b16 v[98:99], v7 offset:1216
    ds_read_b64_tr_b16 v[100:101], v7 offset:9280
    ds_read_b64_tr_b16 v[102:103], v7 offset:10432
    ds_read_b64_tr_b16 v[104:105], v7 offset:18496
    ds_read_b64_tr_b16 v[106:107], v7 offset:19648
    ds_read_b64_tr_b16 v[108:109], v7 offset:27712
    ds_read_b64_tr_b16 v[110:111], v7 offset:28864
    s_waitcnt lgkmcnt(8)
    v_mfma_f32_16x16x32_bf16 v[68:71], v[40:43], v[24:27], 0
    v_mfma_f32_16x16x32_bf16 v[68:71], v[44:47], v[28:31], v[68:71]
    v_mfma_f32_16x16x32_bf16 v[68:71], v[48:51], v[32:35], v[68:71]
    v_mfma_f32_16x16x32_bf16 v[68:71], v[52:55], v[36:39], v[68:71]
    ds_read_b64_tr_b16 v[8:9], v7 offset:96
    ds_read_b64_tr_b16 v[10:11], v7 offset:1248
    ds_read_b64_tr_b16 v[12:13], v7 offset:9312
    ds_read_b64_tr_b16 v[14:15], v7 offset:10464
    ds_read_b64_tr_b16 v[16:17], v7 offset:18528
    ds_read_b64_tr_b16 v[18:19], v7 offset:19680
    ds_read_b64_tr_b16 v[20:21], v7 offset:27744
    ds_read_b64_tr_b16 v[22:23], v7 offset:28896
    s_waitcnt lgkmcnt(8)
    v_mfma_f32_16x16x32_bf16 v[72:75], v[40:43], v[96:99], 0
    v_mfma_f32_16x16x32_bf16 v[72:75], v[44:47], v[100:103], v[72:75]
    v_mfma_f32_16x16x32_bf16 v[72:75], v[48:51], v[104:107], v[72:75]
    v_mfma_f32_16x16x32_bf16 v[72:75], v[52:55], v[108:111], v[72:75]
    ds_read_b64_tr_b16 v[24:25], v7 offset:128
    ds_read_b64_tr_b16 v[26:27], v7 offset:1280
    ds_read_b64_tr_b16 v[28:29], v7 offset:9344
    ds_read_b64_tr_b16 v[30:31], v7 offset:10496
    ds_read_b64_tr_b16 v[32:33], v7 offset:18560
    ds_read_b64_tr_b16 v[34:35], v7 offset:19712
    ds_read_b64_tr_b16 v[36:37], v7 offset:27776
    ds_read_b64_tr_b16 v[38:39], v7 offset:28928
    s_waitcnt lgkmcnt(8)
    v_mfma_f32_16x16x32_bf16 v[76:79], v[40:43], v[8:11], 0
    v_mfma_f32_16x16x32_bf16 v[76:79], v[44:47], v[12:15], v[76:79]
    v_mfma_f32_16x16x32_bf16 v[76:79], v[48:51], v[16:19], v[76:79]
    v_mfma_f32_16x16x32_bf16 v[76:79], v[52:55], v[20:23], v[76:79]
    ds_read_b64_tr_b16 v[96:97], v7 offset:160
    ds_read_b64_tr_b16 v[98:99], v7 offset:1312
    ds_read_b64_tr_b16 v[100:101], v7 offset:9376
    ds_read_b64_tr_b16 v[102:103], v7 offset:10528
    ds_read_b64_tr_b16 v[104:105], v7 offset:18592
    ds_read_b64_tr_b16 v[106:107], v7 offset:19744
    ds_read_b64_tr_b16 v[108:109], v7 offset:27808
    ds_read_b64_tr_b16 v[110:111], v7 offset:28960
    s_waitcnt lgkmcnt(8)
    v_mfma_f32_16x16x32_bf16 v[80:83], v[40:43], v[24:27], 0
    v_mfma_f32_16x16x32_bf16 v[80:83], v[44:47], v[28:31], v[80:83]
    v_mfma_f32_16x16x32_bf16 v[80:83], v[48:51], v[32:35], v[80:83]
    v_mfma_f32_16x16x32_bf16 v[80:83], v[52:55], v[36:39], v[80:83]
    ds_read_b64_tr_b16 v[8:9], v7 offset:192
    ds_read_b64_tr_b16 v[10:11], v7 offset:1344
    ds_read_b64_tr_b16 v[12:13], v7 offset:9408
    ds_read_b64_tr_b16 v[14:15], v7 offset:10560
    ds_read_b64_tr_b16 v[16:17], v7 offset:18624
    ds_read_b64_tr_b16 v[18:19], v7 offset:19776
    ds_read_b64_tr_b16 v[20:21], v7 offset:27840
    ds_read_b64_tr_b16 v[22:23], v7 offset:28992
    s_waitcnt lgkmcnt(8)
    v_mfma_f32_16x16x32_bf16 v[84:87], v[40:43], v[96:99], 0
    v_mfma_f32_16x16x32_bf16 v[84:87], v[44:47], v[100:103], v[84:87]
    v_mfma_f32_16x16x32_bf16 v[84:87], v[48:51], v[104:107], v[84:87]
    v_mfma_f32_16x16x32_bf16 v[84:87], v[52:55], v[108:111], v[84:87]
    ds_read_b64_tr_b16 v[24:25], v7 offset:224
    ds_read_b64_tr_b16 v[26:27], v7 offset:1376
    ds_read_b64_tr_b16 v[28:29], v7 offset:9440
    ds_read_b64_tr_b16 v[30:31], v7 offset:10592
    ds_read_b64_tr_b16 v[32:33], v7 offset:18656
    ds_read_b64_tr_b16 v[34:35], v7 offset:19808
    ds_read_b64_tr_b16 v[36:37], v7 offset:27872
    ds_read_b64_tr_b16 v[38:39], v7 offset:29024
    s_waitcnt lgkmcnt(8)
    v_mfma_f32_16x16x32_bf16 v[88:91], v[40:43], v[8:11], 0
    v_mfma_f32_16x16x32_bf16 v[88:91], v[44:47], v[12:15], v[88:91]
    v_mfma_f32_16x16x32_bf16 v[88:91], v[48:51], v[16:19], v[88:91]
    v_mfma_f32_16x16x32_bf16 v[88:91], v[52:55], v[20:23], v[88:91]
    s_waitcnt lgkmcnt(0)
    v_mfma_f32_16x16x32_bf16 v[92:95], v[40:43], v[24:27], 0
    v_mfma_f32_16x16x32_bf16 v[92:95], v[44:47], v[28:31], v[92:95]
    v_mfma_f32_16x16x32_bf16 v[92:95], v[48:51], v[32:35], v[92:95]
    v_mfma_f32_16x16x32_bf16 v[92:95], v[52:55], v[36:39], v[92:95]
    s_mov_b32 s40, 0x00800000
    s_mov_b32 s41, 0x7fff0000
    s_mov_b32 s42, 0xbfb8aa3b
    s_movk_i32 s43, 10000
    s_nop 6
    v_mul_f32 v64, s42, v64
    v_mul_f32 v68, s42, v68
    v_mul_f32 v72, s42, v72
    v_mul_f32 v76, s42, v76
    v_cvt_pk_bf16_f32 v8, v64, v68
    v_max_f32_e64 v68, |v68|, s40
    v_cvt_pk_bf16_f32 v9, v72, v76
    v_max_f32_e64 v76, |v76|, s40
    v_cvt_pk_bf16_f32 v10, v80, v84
    v_max_f32_e64 v84, |v84|, s40
    v_cvt_pk_bf16_f32 v11, v88, v92
    v_max_f32_e64 v92, |v92|, s40
    v_add_u32 v68, 0x8000, v68
    v_add_u32 v76, 0x8000, v76
    v_add_u32 v84, 0x8000, v84
    v_add_u32 v92, 0x8000, v92
    v_sub_u32_sdwa v68, v68, v8 dst_sel:DWORD dst_unused:UNUSED_PAD src0_sel:DWORD src1_sel:WORD_0
    v_sub_u32_sdwa v76, v76, v9 dst_sel:DWORD dst_unused:UNUSED_PAD src0_sel:DWORD src1_sel:WORD_0
    v_sub_u32_sdwa v84, v84, v10 dst_sel:DWORD dst_unused:UNUSED_PAD src0_sel:DWORD src1_sel:WORD_0
    v_sub_u32_sdwa v92, v92, v11 dst_sel:DWORD dst_unused:UNUSED_PAD src0_sel:DWORD src1_sel:WORD_0
    v_add_u32 v2, 0, v1
    v_cmp_ge_u32 vcc, s43, v2
    v_bfi_b32 v8, s41, v68, v8
    v_bfi_b32 v9, s41, v76, v9
    v_bfi_b32 v10, s41, v84, v10
    v_bfi_b32 v11, s41, v92, v11
    s_and_saveexec_b64 s[44:45], vcc
    s_cbranch_execz K1_TAB_SKIP0
    buffer_store_dwordx4 v[8:11], v6, s[32:35], s3 offen offset:0 sc1
K1_TAB_SKIP0:
    s_mov_b64 exec, s[44:45]
    v_mul_f32 v65, s42, v65
    v_mul_f32 v69, s42, v69
    v_mul_f32 v73, s42, v73
    v_mul_f32 v77, s42, v77
    v_cvt_pk_bf16_f32 v16, v65, v69
    v_max_f32_e64 v69, |v69|, s40
    v_cvt_pk_bf16_f32 v17, v73, v77
    v_max_f32_e64 v77, |v77|, s40
    v_cvt_pk_bf16_f32 v18, v81, v85
    v_max_f32_e64 v85, |v85|, s40
    v_cvt_pk_bf16_f32 v19, v89, v93
    v_max_f32_e64 v93, |v93|, s40
    v_add_u32 v69, 0x8000, v69
    v_add_u32 v77, 0x8000, v77
    v_add_u32 v85, 0x8000, v85
    v_add_u32 v93, 0x8000, v93
    v_sub_u32_sdwa v69, v69, v16 dst_sel:DWORD dst_unused:UNUSED_PAD src0_sel:DWORD src1_sel:WORD_0
    v_sub_u32_sdwa v77, v77, v17 dst_sel:DWORD dst_unused:UNUSED_PAD src0_sel:DWORD src1_sel:WORD_0
    v_sub_u32_sdwa v85, v85, v18 dst_sel:DWORD dst_unused:UNUSED_PAD src0_sel:DWORD src1_sel:WORD_0
    v_sub_u32_sdwa v93, v93, v19 dst_sel:DWORD dst_unused:UNUSED_PAD src0_sel:DWORD src1_sel:WORD_0
    v_add_u32 v2, 1, v1
    v_cmp_ge_u32 vcc, s43, v2
    v_bfi_b32 v16, s41, v69, v16
    v_bfi_b32 v17, s41, v77, v17
    v_bfi_b32 v18, s41, v85, v18
    v_bfi_b32 v19, s41, v93, v19
    s_and_saveexec_b64 s[44:45], vcc
    s_cbranch_execz K1_TAB_SKIP1
    buffer_store_dwordx4 v[16:19], v6, s[32:35], s3 offen offset:256 sc1
K1_TAB_SKIP1:
    s_mov_b64 exec, s[44:45]
    v_mul_f32 v66, s42, v66
    v_mul_f32 v70, s42, v70
    v_mul_f32 v74, s42, v74
    v_mul_f32 v78, s42, v78
    v_cvt_pk_bf16_f32 v8, v66, v70
    v_max_f32_e64 v70, |v70|, s40
    v_cvt_pk_bf16_f32 v9, v74, v78
    v_max_f32_e64 v78, |v78|, s40
    v_cvt_pk_bf16_f32 v10, v82, v86
    v_max_f32_e64 v86, |v86|, s40
    v_cvt_pk_bf16_f32 v11, v90, v94
    v_max_f32_e64 v94, |v94|, s40
    v_add_u32 v70, 0x8000, v70
    v_add_u32 v78, 0x8000, v78
    v_add_u32 v86, 0x8000, v86
    v_add_u32 v94, 0x8000, v94
    v_sub_u32_sdwa v70, v70, v8 dst_sel:DWORD dst_unused:UNUSED_PAD src0_sel:DWORD src1_sel:WORD_0
    v_sub_u32_sdwa v78, v78, v9 dst_sel:DWORD dst_unused:UNUSED_PAD src0_sel:DWORD src1_sel:WORD_0
    v_sub_u32_sdwa v86, v86, v10 dst_sel:DWORD dst_unused:UNUSED_PAD src0_sel:DWORD src1_sel:WORD_0
    v_sub_u32_sdwa v94, v94, v11 dst_sel:DWORD dst_unused:UNUSED_PAD src0_sel:DWORD src1_sel:WORD_0
    v_add_u32 v2, 2, v1
    v_cmp_ge_u32 vcc, s43, v2
    v_bfi_b32 v8, s41, v70, v8
    v_bfi_b32 v9, s41, v78, v9
    v_bfi_b32 v10, s41, v86, v10
    v_bfi_b32 v11, s41, v94, v11
    s_and_saveexec_b64 s[44:45], vcc
    s_cbranch_execz K1_TAB_SKIP2
    buffer_store_dwordx4 v[8:11], v6, s[32:35], s3 offen offset:512 sc1
K1_TAB_SKIP2:
    s_mov_b64 exec, s[44:45]
    v_mul_f32 v67, s42, v67
    v_mul_f32 v71, s42, v71
    v_mul_f32 v75, s42, v75
    v_mul_f32 v79, s42, v79
    v_cvt_pk_bf16_f32 v16, v67, v71
    v_max_f32_e64 v71, |v71|, s40
    v_cvt_pk_bf16_f32 v17, v75, v79
    v_max_f32_e64 v79, |v79|, s40
    v_cvt_pk_bf16_f32 v18, v83, v87
    v_max_f32_e64 v87, |v87|, s40
    v_cvt_pk_bf16_f32 v19, v91, v95
    v_max_f32_e64 v95, |v95|, s40
    v_add_u32 v71, 0x8000, v71
    v_add_u32 v79, 0x8000, v79
    v_add_u32 v87, 0x8000, v87
    v_add_u32 v95, 0x8000, v95
    v_sub_u32_sdwa v71, v71, v16 dst_sel:DWORD dst_unused:UNUSED_PAD src0_sel:DWORD src1_sel:WORD_0
    v_sub_u32_sdwa v79, v79, v17 dst_sel:DWORD dst_unused:UNUSED_PAD src0_sel:DWORD src1_sel:WORD_0
    v_sub_u32_sdwa v87, v87, v18 dst_sel:DWORD dst_unused:UNUSED_PAD src0_sel:DWORD src1_sel:WORD_0
    v_sub_u32_sdwa v95, v95, v19 dst_sel:DWORD dst_unused:UNUSED_PAD src0_sel:DWORD src1_sel:WORD_0
    v_add_u32 v2, 3, v1
    v_cmp_ge_u32 vcc, s43, v2
    v_bfi_b32 v16, s41, v71, v16
    v_bfi_b32 v17, s41, v79, v17
    v_bfi_b32 v18, s41, v87, v18
    v_bfi_b32 v19, s41, v95, v19
    s_and_saveexec_b64 s[44:45], vcc
    s_cbranch_execz K1_TAB_SKIP3
    buffer_store_dwordx4 v[16:19], v6, s[32:35], s3 offen offset:768 sc1
K1_TAB_SKIP3:
    s_mov_b64 exec, s[44:45]
    s_endpgm
K1_BIN:
    v_lshrrev_b32 v1, 8, v0
    s_sub_u32 s3, s2, 158
    v_readfirstlane_b32 s45, v1
    v_and_b32 v0, 255, v0
    s_mov_b32 s20, s8
    s_and_b32 s21, s9, 0xffff
    s_mov_b32 s22, 1280000
    s_mov_b32 s23, 0x00020000
    s_mov_b32 s24, s10
    s_and_b32 s25, s11, 0xffff
    s_mov_b32 s26, 1280000
    s_mov_b32 s27, 0x00020000
    s_mov_b32 s28, s18
    s_and_b32 s29, s19, 0xffff
    s_mov_b32 s30, 18874368
    s_mov_b32 s31, 0x00020000
    s_lshl_b32 s3, s3, 1
    s_add_u32 s3, s3, s45
    s_mul_i32 s46, s45, 7168
    v_lshlrev_b32 v1, 2, v0
    s_mul_i32 s32, s3, 5120
    s_add_u32 s33, s32, 4096
    buffer_load_dword v8, v1, s[24:27], s32 offen offset:0
    buffer_load_dword v9, v1, s[24:27], s32 offen offset:1024
    buffer_load_dword v10, v1, s[24:27], s32 offen offset:2048
    buffer_load_dword v11, v1, s[24:27], s32 offen offset:3072
    buffer_load_dword v12, v1, s[24:27], s33 offen
    buffer_load_dword v16, v1, s[20:23], s32 offen offset:0
    buffer_load_dword v17, v1, s[20:23], s32 offen offset:1024
    buffer_load_dword v18, v1, s[20:23], s32 offen offset:2048
    buffer_load_dword v19, v1, s[20:23], s32 offen offset:3072
    buffer_load_dword v20, v1, s[20:23], s33 offen
    v_mov_b32 v2, 0
    v_add_u32 v6, s46, v1
    ds_write_b32 v6, v2 offset:0
    v_mov_b32 v7, s46
    s_mov_b32 s34, 52429
    s_waitcnt lgkmcnt(0)
    s_barrier
    v_mov_b32 v3, 1
    s_waitcnt vmcnt(9)
    v_mul_u32_u24 v24, s34, v8
    v_lshrrev_b32 v24, 21, v24
    v_mul_u32_u24 v4, 40, v24
    v_sub_u32 v8, v8, v4
    v_lshl_add_u32 v24, v24, 2, v7
    ds_add_rtn_u32 v32, v24, v3 offset:0
    s_waitcnt vmcnt(8)
    v_mul_u32_u24 v25, s34, v9
    v_lshrrev_b32 v25, 21, v25
    v_mul_u32_u24 v4, 40, v25
    v_sub_u32 v9, v9, v4
    v_lshl_add_u32 v25, v25, 2, v7
    ds_add_rtn_u32 v33, v25, v3 offset:0
    s_waitcnt vmcnt(7)
    v_mul_u32_u24 v26, s34, v10
    v_lshrrev_b32 v26, 21, v26
    v_mul_u32_u24 v4, 40, v26
    v_sub_u32 v10, v10, v4
    v_lshl_add_u32 v26, v26, 2, v7
    ds_add_rtn_u32 v34, v26, v3 offset:0
    s_waitcnt vmcnt(6)
    v_mul_u32_u24 v27, s34, v11
    v_lshrrev_b32 v27, 21, v27
    v_mul_u32_u24 v4, 40, v27
    v_sub_u32 v11, v11, v4
    v_lshl_add_u32 v27, v27, 2, v7
    ds_add_rtn_u32 v35, v27, v3 offset:0
    s_waitcnt vmcnt(5)
    v_mul_u32_u24 v28, s34, v12
    v_lshrrev_b32 v28, 21, v28
    v_mul_u32_u24 v4, 40, v28
    v_sub_u32 v12, v12, v4
    v_lshl_add_u32 v28, v28, 2, v7
    ds_add_rtn_u32 v36, v28, v3 offset:0
    s_waitcnt vmcnt(4)
    v_lshl_or_b32 v16, v8, 14, v16
    v_add_u32 v4, 0, v0
    v_lshl_or_b32 v16, v4, 20, v16
    s_waitcnt vmcnt(3)
    v_lshl_or_b32 v17, v9, 14, v17
    v_add_u32 v4, 256, v0
    v_lshl_or_b32 v17, v4, 20, v17
    s_waitcnt vmcnt(2)
    v_lshl_or_b32 v18, v10, 14, v18
    v_add_u32 v4, 512, v0
    v_lshl_or_b32 v18, v4, 20, v18
    s_waitcnt vmcnt(1)
    v_lshl_or_b32 v19, v11, 14, v19
    v_add_u32 v4, 768, v0
    v_lshl_or_b32 v19, v4, 20, v19
    s_waitcnt vmcnt(0)
    v_lshl_or_b32 v20, v12, 14, v20
    v_add_u32 v4, 1024, v0
    v_lshl_or_b32 v20, v4, 20, v20
    v_and_b32 v5, 63, v0
    v_lshlrev_b32 v5, 4, v5
    v_add_u32 v6, v5, v7
    s_waitcnt lgkmcnt(0)
    s_barrier
    ds_read_b128 v[40:43], v6 offset:0
    s_lshr_b32 s47, s46, 2
    s_waitcnt lgkmcnt(0)
    v_add_u32 v44, v40, v41
    v_add_u32 v45, v42, v43
    v_add_u32 v46, v44, v45
    v_mov_b32 v47, v46
    s_nop 1
    v_add_u32_dpp v47, v47, v47 row_shr:1 row_mask:0xf bank_mask:0xf bound_ctrl:1
    s_nop 1
    v_add_u32_dpp v47, v47, v47 row_shr:2 row_mask:0xf bank_mask:0xf bound_ctrl:1
    s_nop 1
    v_add_u32_dpp v47, v47, v47 row_shr:4 row_mask:0xf bank_mask:0xf bound_ctrl:1
    s_nop 1
    v_add_u32_dpp v47, v47, v47 row_shr:8 row_mask:0xf bank_mask:0xf bound_ctrl:1
    s_nop 1
    v_add_u32_dpp v47, v47, v47 row_bcast:15 row_mask:0xa bank_mask:0xf
    s_nop 1
    v_add_u32_dpp v47, v47, v47 row_bcast:31 row_mask:0xc bank_mask:0xf
    v_sub_u32 v48, v47, v46
    v_add_u32 v49, v48, v40
    v_add_u32 v50, v48, v44
    v_add_u32 v51, v50, v42
    v_add_u32 v56, s47, v48
    v_add_u32 v57, s47, v49
    v_add_u32 v58, s47, v50
    v_add_u32 v59, s47, v51
    ds_write_b128 v6, v[56:59] offset:1024
    v_readfirstlane_b32 s35, v0
    s_lshl_b32 s36, s3, 10
    s_add_u32 s36, s36, 6553600
    s_cmp_ge_u32 s35, 64
    s_cbranch_scc1 K1_BIN_NOPUB
    v_lshl_or_b32 v52, v40, 16, v48
    v_lshl_or_b32 v53, v41, 16, v49
    v_lshl_or_b32 v54, v42, 16, v50
    v_lshl_or_b32 v55, v43, 16, v51
    buffer_store_dwordx4 v[52:55], v5, s[28:31], s36 offen sc1
K1_BIN_NOPUB:
    s_waitcnt lgkmcnt(0)
    ds_read_b32 v40, v24 offset:1024
    ds_read_b32 v41, v25 offset:1024
    ds_read_b32 v42, v26 offset:1024
    ds_read_b32 v43, v27 offset:1024
    ds_read_b32 v44, v28 offset:1024
    s_waitcnt lgkmcnt(4)
    v_add_lshl_u32 v40, v40, v32, 2
    ds_write_b32 v40, v16 offset:2048
    s_waitcnt lgkmcnt(3)
    v_add_lshl_u32 v41, v41, v33, 2
    ds_write_b32 v41, v17 offset:2048
    s_waitcnt lgkmcnt(2)
    v_add_lshl_u32 v42, v42, v34, 2
    ds_write_b32 v42, v18 offset:2048
    s_waitcnt lgkmcnt(1)
    v_add_lshl_u32 v43, v43, v35, 2
    ds_write_b32 v43, v19 offset:2048
    s_waitcnt lgkmcnt(0)
    v_add_lshl_u32 v44, v44, v36, 2
    ds_write_b32 v44, v20 offset:2048
    v_lshlrev_b32 v5, 4, v0
    v_add_u32 v6, v5, v7
    s_waitcnt lgkmcnt(0)
    s_barrier
    ds_read_b128 v[40:43], v6 offset:2048
    ds_read_b128 v[44:47], v6 offset:6144
    s_add_u32 s36, s32, 5242880
    s_add_u32 s37, s36, 4096
    v_cmp_gt_u32 vcc, 64, v0
    s_waitcnt lgkmcnt(1)
    buffer_store_dwordx4 v[40:43], v5, s[28:31], s36 offen sc1
    s_and_saveexec_b64 s[38:39], vcc
    s_cbranch_execz K1_BIN_END
    s_waitcnt lgkmcnt(0)
    buffer_store_dwordx4 v[44:47], v5, s[28:31], s37 offen sc1
K1_BIN_END:
    s_mov_b64 exec, -1
    s_endpgm
K1_WF:
    s_sub_u32 s3, s2, 283
    v_lshrrev_b32 v1, 6, v0
    s_nop 0
    v_readfirstlane_b32 s28, v1
    s_lshl_b32 s3, s3, 3
    s_add_u32 s3, s3, s28
    s_lshr_b32 s29, s3, 1
    s_and_b32 s30, s3, 1
    s_cmp_lt_u32 s29, 8
    s_cselect_b32 s20, s16, s12
    s_cselect_b32 s21, s17, s13
    s_and_b32 s21, s21, 0xffff
    s_mov_b32 s22, 32768
    s_mov_b32 s23, 0x00020000
    s_mov_b32 s24, s18
    s_and_b32 s25, s19, 0xffff
    s_mov_b32 s26, 18874368
    s_mov_b32 s27, 0x00020000
    v_and_b32 v2, 15, v0
    v_bfe_u32 v3, v0, 4, 2
    s_and_b32 s31, s29, 7
    s_lshl_b32 s31, s31, 5
    s_lshl_b32 s32, s30, 14
    s_add_u32 s31, s31, s32
    v_lshlrev_b32 v4, 11, v3
    v_lshl_add_u32 v4, v2, 1, v4
    s_add_u32 s33, s31, 8192
    buffer_load_ushort v8, v4, s[20:23], s31 offen offset:0
    buffer_load_ushort v9, v4, s[20:23], s31 offen offset:256
    buffer_load_ushort v10, v4, s[20:23], s31 offen offset:512
    buffer_load_ushort v11, v4, s[20:23], s31 offen offset:768
    buffer_load_ushort v12, v4, s[20:23], s31 offen offset:1024
    buffer_load_ushort v13, v4, s[20:23], s31 offen offset:1280
    buffer_load_ushort v14, v4, s[20:23], s31 offen offset:1536
    buffer_load_ushort v15, v4, s[20:23], s31 offen offset:1792
    buffer_load_ushort v16, v4, s[20:23], s33 offen offset:0
    buffer_load_ushort v17, v4, s[20:23], s33 offen offset:256
    buffer_load_ushort v18, v4, s[20:23], s33 offen offset:512
    buffer_load_ushort v19, v4, s[20:23], s33 offen offset:768
    buffer_load_ushort v20, v4, s[20:23], s33 offen offset:1024
    buffer_load_ushort v21, v4, s[20:23], s33 offen offset:1280
    buffer_load_ushort v22, v4, s[20:23], s33 offen offset:1536
    buffer_load_ushort v23, v4, s[20:23], s33 offen offset:1792
    v_and_b32 v5, 63, v0
    v_lshlrev_b32 v5, 4, v5
    s_lshl_b32 s34, s3, 11
    s_add_u32 s34, s34, 6815744
    s_cmp_lt_u32 s29, 8
    s_cselect_b32 s35, 1.0, 0x4c800000
    s_mov_b32 s36, 0x07060302
    s_waitcnt vmcnt(8)
    v_lshlrev_b32 v8, 16, v8
    v_mul_f32 v8, s35, v8
    v_lshlrev_b32 v9, 16, v9
    v_mul_f32 v9, s35, v9
    v_lshlrev_b32 v10, 16, v10
    v_mul_f32 v10, s35, v10
    v_lshlrev_b32 v11, 16, v11
    v_mul_f32 v11, s35, v11
    v_lshlrev_b32 v12, 16, v12
    v_mul_f32 v12, s35, v12
    v_lshlrev_b32 v13, 16, v13
    v_mul_f32 v13, s35, v13
    v_lshlrev_b32 v14, 16, v14
    v_mul_f32 v14, s35, v14
    v_lshlrev_b32 v15, 16, v15
    v_mul_f32 v15, s35, v15
    v_perm_b32 v24, v9, v8, s36
    v_perm_b32 v25, v11, v10, s36
    v_perm_b32 v26, v13, v12, s36
    v_perm_b32 v27, v15, v14, s36
    buffer_store_dwordx4 v[24:27], v5, s[24:27], s34 offen offset:0 sc1
    s_waitcnt vmcnt(1)
    v_lshlrev_b32 v16, 16, v16
    v_mul_f32 v16, s35, v16
    v_lshlrev_b32 v17, 16, v17
    v_mul_f32 v17, s35, v17
    v_lshlrev_b32 v18, 16, v18
    v_mul_f32 v18, s35, v18
    v_lshlrev_b32 v19, 16, v19
    v_mul_f32 v19, s35, v19
    v_lshlrev_b32 v20, 16, v20
    v_mul_f32 v20, s35, v20
    v_lshlrev_b32 v21, 16, v21
    v_mul_f32 v21, s35, v21
    v_lshlrev_b32 v22, 16, v22
    v_mul_f32 v22, s35, v22
    v_lshlrev_b32 v23, 16, v23
    v_mul_f32 v23, s35, v23
    v_perm_b32 v28, v17, v16, s36
    v_perm_b32 v29, v19, v18, s36
    v_perm_b32 v30, v21, v20, s36
    v_perm_b32 v31, v23, v22, s36
    buffer_store_dwordx4 v[28:31], v5, s[24:27], s34 offen offset:1024 sc1
    s_endpgm
K1_CF:
    v_lshrrev_b32 v1, 6, v0
    s_nop 0
    v_readfirstlane_b32 s28, v1
    s_nop 3
    s_cmp_ge_u32 s28, 4
    s_cbranch_scc1 K1_CF_END
    s_mov_b32 s20, s16
    s_and_b32 s21, s17, 0xffff
    s_mov_b32 s22, 69632
    s_mov_b32 s23, 0x00020000
    s_mov_b32 s24, s18
    s_and_b32 s25, s19, 0xffff
    s_mov_b32 s26, 18874368
    s_mov_b32 s27, 0x00020000
    v_and_b32 v2, 15, v0
    v_bfe_u32 v3, v0, 4, 2
    v_and_b32 v4, 1, v3
    v_lshlrev_b32 v4, 11, v4
    v_lshl_add_u32 v4, v2, 1, v4
    s_lshl_b32 s29, s28, 6
    s_add_u32 s29, s29, 65536
    buffer_load_ushort v8, v4, s[20:23], s29 offen offset:0
    buffer_load_ushort v9, v4, s[20:23], s29 offen offset:256
    buffer_load_ushort v10, v4, s[20:23], s29 offen offset:512
    buffer_load_ushort v11, v4, s[20:23], s29 offen offset:768
    buffer_load_ushort v12, v4, s[20:23], s29 offen offset:1024
    buffer_load_ushort v13, v4, s[20:23], s29 offen offset:1280
    buffer_load_ushort v14, v4, s[20:23], s29 offen offset:1536
    buffer_load_ushort v15, v4, s[20:23], s29 offen offset:1792
    buffer_load_ushort v16, v4, s[20:23], s29 offen offset:32
    buffer_load_ushort v17, v4, s[20:23], s29 offen offset:288
    buffer_load_ushort v18, v4, s[20:23], s29 offen offset:544
    buffer_load_ushort v19, v4, s[20:23], s29 offen offset:800
    buffer_load_ushort v20, v4, s[20:23], s29 offen offset:1056
    buffer_load_ushort v21, v4, s[20:23], s29 offen offset:1312
    buffer_load_ushort v22, v4, s[20:23], s29 offen offset:1568
    buffer_load_ushort v23, v4, s[20:23], s29 offen offset:1824
    v_and_b32 v5, 63, v0
    v_lshlrev_b32 v5, 4, v5
    s_lshl_b32 s34, s28, 11
    s_add_u32 s34, s34, 6881280
    s_mov_b32 s30, 0xbfb8aa3b
    v_cmp_gt_u32 vcc, 2, v3
    v_cmp_eq_u32 s[32:33], 2, v3
    v_mov_b32 v6, 0xc1d0
    v_mov_b32 v7, 0
    s_waitcnt vmcnt(0)
    v_lshlrev_b32 v8, 16, v8
    v_mul_f32 v8, s30, v8
    v_lshlrev_b32 v9, 16, v9
    v_mul_f32 v9, s30, v9
    v_lshlrev_b32 v10, 16, v10
    v_mul_f32 v10, s30, v10
    v_lshlrev_b32 v11, 16, v11
    v_mul_f32 v11, s30, v11
    v_lshlrev_b32 v12, 16, v12
    v_mul_f32 v12, s30, v12
    v_lshlrev_b32 v13, 16, v13
    v_mul_f32 v13, s30, v13
    v_lshlrev_b32 v14, 16, v14
    v_mul_f32 v14, s30, v14
    v_lshlrev_b32 v15, 16, v15
    v_mul_f32 v15, s30, v15
    v_cvt_pk_bf16_f32 v24, v8, v9
    v_cvt_pk_bf16_f32 v25, v10, v11
    v_cvt_pk_bf16_f32 v26, v12, v13
    v_cvt_pk_bf16_f32 v27, v14, v15
    v_cndmask_b32 v32, v7, v6, s[32:33]
    v_cndmask_b32 v24, v7, v24, vcc
    v_cndmask_b32 v25, v7, v25, vcc
    v_cndmask_b32 v26, v32, v26, vcc
    v_cndmask_b32 v27, v7, v27, vcc
    buffer_store_dwordx4 v[24:27], v5, s[24:27], s34 offen offset:0 sc1
    v_lshlrev_b32 v16, 16, v16
    v_mul_f32 v16, s30, v16
    v_lshlrev_b32 v17, 16, v17
    v_mul_f32 v17, s30, v17
    v_lshlrev_b32 v18, 16, v18
    v_mul_f32 v18, s30, v18
    v_lshlrev_b32 v19, 16, v19
    v_mul_f32 v19, s30, v19
    v_lshlrev_b32 v20, 16, v20
    v_mul_f32 v20, s30, v20
    v_lshlrev_b32 v21, 16, v21
    v_mul_f32 v21, s30, v21
    v_lshlrev_b32 v22, 16, v22
    v_mul_f32 v22, s30, v22
    v_lshlrev_b32 v23, 16, v23
    v_mul_f32 v23, s30, v23
    v_cvt_pk_bf16_f32 v28, v16, v17
    v_cvt_pk_bf16_f32 v29, v18, v19
    v_cvt_pk_bf16_f32 v30, v20, v21
    v_cvt_pk_bf16_f32 v31, v22, v23
    v_cndmask_b32 v32, v7, v6, s[32:33]
    v_cndmask_b32 v28, v7, v28, vcc
    v_cndmask_b32 v29, v7, v29, vcc
    v_cndmask_b32 v30, v32, v30, vcc
    v_cndmask_b32 v31, v7, v31, vcc
    buffer_store_dwordx4 v[28:31], v5, s[24:27], s34 offen offset:1024 sc1
    s_cmp_eq_u32 s28, 0
    s_cbranch_scc0 K1_CF_END
    v_lshrrev_b32 v8, 2, v2
    v_subrev_u32 v9, 2, v3
    v_lshlrev_b32 v9, 1, v9
    v_mov_b32 v10, 0x3f803f80
    v_cmp_eq_u32 vcc, v8, v9
    v_add_u32 v9, 1, v9
    v_cmp_eq_u32 s[36:37], v8, v9
    v_cndmask_b32 v12, v7, v10, vcc
    v_mov_b32 v11, 0x3f80
    v_cndmask_b32 v13, v7, v10, s[36:37]
    v_cndmask_b32 v14, v7, v11, s[32:33]
    v_mov_b32 v15, 0
    s_mov_b32 s34, 6889472
    buffer_store_dwordx4 v[12:15], v5, s[24:27], s34 offen sc1
K1_CF_END:
    s_endpgm
.globl egc_main_kernel
.p2align 8
.type egc_main_kernel,@function
egc_main_kernel:
    s_cmp_ge_u32 s2, 250
    s_cbranch_scc1 K2_EXIT
    s_load_dwordx4 s[4:7], s[0:1], 0
    s_load_dwordx2 s[8:9], s[0:1], 56
    s_load_dwordx2 s[10:11], s[0:1], 72
    v_lshrrev_b32 v1, 6, v0
    v_lshlrev_b32 v3, 4, v0
    s_and_b32 s46, s2, 7
    v_readfirstlane_b32 s28, v1
    s_lshr_b32 s47, s2, 3
    s_sub_u32 s48, s46, 2
    s_max_i32 s48, s48, 0
    s_lshl_b32 s46, s46, 5
    s_sub_u32 s46, s46, s48
    s_add_u32 s29, s46, s47
    v_and_b32 v120, 0x3f0, v3
    v_mov_b32 v8, v3
    v_bfe_u32 v9, v120, 4, 4
    v_lshrrev_b32 v10, 8, v120
    v_lshlrev_b32 v116, 4, v9
    v_lshlrev_b32 v3, 4, v10
    v_lshl_add_u32 v2, v9, 5, v3
    v_and_b32 v5, 16, v120
    v_lshrrev_b32 v4, 5, v120
    s_mov_b64 s[30:31], 0xffffffff
    s_mov_b32 s32, 0
    s_mov_b32 s33, -1
    s_mov_b32 s34, 0x32800000
    s_mov_b32 s35, 0x32800000
    s_mov_b32 s44, 0
    s_mov_b32 s63, 0
    s_cmp_ge_u32 s28, 8
    s_cbranch_scc1 K2_G
    v_mov_b32 v15, 0
    v_lshrrev_b32 v16, 2, v8
    v_cmp_gt_u32 vcc, 128, v0
    v_lshrrev_b32 v12, 1, v0
    s_and_saveexec_b64 s[54:55], vcc
    ds_write_b32 v16, v15 offset:0
    s_mov_b64 exec, -1
    v_lshlrev_b32 v13, 10, v12
    s_lshl_b32 s56, s29, 2
    s_add_u32 s56, s56, 6553600
    s_mov_b32 s60, 5242880
    v_and_b32 v33, 1, v0
    v_mul_u32_u24 v39, 1280, v12
    s_waitcnt lgkmcnt(0)
    s_mov_b32 s24, s10
    s_and_b32 s25, s11, 0xffff
    s_mov_b32 s26, 18874368
    s_mov_b32 s27, 0x00020000
    buffer_load_dword v14, v13, s[24:27], s56 offen
    s_barrier
    v_cmp_gt_u32 vcc, 250, v12
    v_cmp_eq_u32 s[54:55], 0, v33
    v_mov_b32 v16, 256
    v_mul_u32_u24 v34, 40960, v12
    v_mov_b32 v37, 0
    s_mov_b32 s16, s6
    s_and_b32 s17, s7, 0xffff
    s_mov_b32 s18, 10240000
    s_mov_b32 s19, 0x00020000
    s_mov_b32 s20, s8
    s_and_b32 s21, s9, 0xffff
    s_mov_b32 s22, 2560000
    s_mov_b32 s23, 0x00020000
    s_waitcnt vmcnt(0)
    v_lshrrev_b32 v32, 16, v14
    v_and_b32 v14, 0xffff, v14
    v_cndmask_b32 v32, 0, v32, vcc
    v_add_u32 v39, v39, v14
    v_lshlrev_b32 v38, 2, v39
    v_lshl_add_u32 v35, v33, 5, v38
    v_lshl_add_u32 v38, v33, 3, v38
    buffer_load_dwordx4 v[56:59], v35, s[24:27], s60 offen
    buffer_load_dwordx4 v[60:63], v35, s[24:27], s60 offen offset:16
    buffer_load_dwordx2 v[64:65], v38, s[24:27], s60 offen offset:64
    s_mov_b64 exec, s[54:55]
    ds_add_rtn_u32 v36, v16, v32
    s_mov_b64 exec, -1
    s_barrier
    s_waitcnt lgkmcnt(0)
    v_mov_b32_dpp v36, v36 quad_perm:[0,0,2,2] row_mask:0xf bank_mask:0xf
    s_nop 0
    v_mov_b32 v121, v36
    s_waitcnt vmcnt(0)
K2_WINDOW:
    s_add_u32 s56, s44, 1500
    v_sub_u32 v66, s56, v36
    v_min_i32 v66, v66, v32
K2_COPY:
    v_add_u32 v67, v36, v37
    v_subrev_u32 v67, s44, v67
    v_sub_u32 v68, v66, v37
    v_lshlrev_b32 v69, 3, v33
    v_sub_u32 v70, v68, v69
    v_add_lshl_u32 v69, v67, v69, 3
    v_add_u32 v69, 103808, v69
    v_lshlrev_b32 v71, 1, v33
    v_sub_u32 v68, v68, v71
    v_add_lshl_u32 v71, v67, v71, 3
    v_add_u32 v71, 103936, v71
    v_cmp_lt_i32 vcc, 0, v70
    s_and_b64 exec, exec, vcc
    s_cbranch_execz K2_CPA
    ds_write2_b32 v69, v56, v34 offset0:0 offset1:1
    v_cmp_lt_i32 vcc, 1, v70
    s_and_b64 exec, exec, vcc
    s_cbranch_execz K2_CPA
    ds_write2_b32 v69, v57, v34 offset0:2 offset1:3
    v_cmp_lt_i32 vcc, 2, v70
    s_and_b64 exec, exec, vcc
    s_cbranch_execz K2_CPA
    ds_write2_b32 v69, v58, v34 offset0:4 offset1:5
    v_cmp_lt_i32 vcc, 3, v70
    s_and_b64 exec, exec, vcc
    s_cbranch_execz K2_CPA
    ds_write2_b32 v69, v59, v34 offset0:6 offset1:7
    v_cmp_lt_i32 vcc, 4, v70
    s_and_b64 exec, exec, vcc
    s_cbranch_execz K2_CPA
    ds_write2_b32 v69, v60, v34 offset0:8 offset1:9
    v_cmp_lt_i32 vcc, 5, v70
    s_and_b64 exec, exec, vcc
    s_cbranch_execz K2_CPA
    ds_write2_b32 v69, v61, v34 offset0:10 offset1:11
    v_cmp_lt_i32 vcc, 6, v70
    s_and_b64 exec, exec, vcc
    s_cbranch_execz K2_CPA
    ds_write2_b32 v69, v62, v34 offset0:12 offset1:13
    v_cmp_lt_i32 vcc, 7, v70
    s_and_b64 exec, exec, vcc
    s_cbranch_execz K2_CPA
    ds_write2_b32 v69, v63, v34 offset0:14 offset1:15
K2_CPA:
    s_mov_b64 exec, -1
    v_cmp_lt_i32 vcc, 16, v68
    s_and_b64 exec, exec, vcc
    s_cbranch_execz K2_CPB
    ds_write2_b32 v71, v64, v34 offset0:0 offset1:1
    v_cmp_lt_i32 vcc, 17, v68
    s_and_b64 exec, exec, vcc
    s_cbranch_execz K2_CPB
    ds_write2_b32 v71, v65, v34 offset0:2 offset1:3
K2_CPB:
    s_mov_b64 exec, -1
    v_add_u32 v37, 20, v37
    v_cmp_lt_i32 vcc, v37, v66
    s_cmp_eq_u64 vcc, 0
    s_cbranch_scc1 K2_COPIED
    v_add_u32 v35, 80, v35
    v_add_u32 v38, 80, v38
    s_mov_b32 s60, 5242880
    buffer_load_dwordx4 v[56:59], v35, s[24:27], s60 offen
    buffer_load_dwordx4 v[60:63], v35, s[24:27], s60 offen offset:16
    buffer_load_dwordx2 v[64:65], v38, s[24:27], s60 offen offset:64
    s_waitcnt vmcnt(0)
    s_branch K2_COPY
K2_COPIED:
    v_mov_b32 v70, 256
    s_waitcnt lgkmcnt(0)
    s_barrier
    ds_read_b32 v70, v70
    s_lshr_b32 s56, s2, 3
    s_mul_i32 s56, s56, 81920
    s_lshl_b32 s57, s28, 13
    s_add_u32 s57, s57, s56
    v_lshlrev_b32 v7, 3, v120
    buffer_load_dword v7, v7, s[24:27], s57 offen
    v_lshlrev_b32 v68, 3, v0
    v_add_u32 v68, 103808, v68
    ds_read_b64 v[56:57], v68 offset:0
    ds_read_b64 v[58:59], v68 offset:4096
    ds_read_b64 v[60:61], v68 offset:8192
    v_mov_b32 v69, 1
    s_waitcnt lgkmcnt(3)
    v_readfirstlane_b32 s43, v70
    v_add_u32 v71, 512, v0
    v_add_u32 v72, 1024, v0
    s_sub_u32 s56, s43, s44
    s_min_u32 s56, s56, 1500
    v_cmp_gt_u32 s[46:47], s56, v0
    v_cmp_gt_u32 s[48:49], s56, v71
    v_cmp_gt_u32 s[50:51], s56, v72
    s_waitcnt lgkmcnt(2)
    v_bfe_u32 v62, v56, 14, 6
    v_lshlrev_b32 v62, 2, v62
    s_mov_b64 exec, s[46:47]
    s_cbranch_execz K2_RK_1
    ds_add_rtn_u32 v65, v62, v69 offset:0
K2_RK_1:
    s_mov_b64 exec, -1
    s_waitcnt lgkmcnt(0)
    v_bfe_u32 v63, v58, 14, 6
    v_lshlrev_b32 v63, 2, v63
    s_mov_b64 exec, s[48:49]
    s_cbranch_execz K2_RK_2
    ds_add_rtn_u32 v66, v63, v69 offset:0
K2_RK_2:
    s_mov_b64 exec, -1
    v_bfe_u32 v64, v60, 14, 6
    v_lshlrev_b32 v64, 2, v64
    s_mov_b64 exec, s[50:51]
    s_cbranch_execz K2_RK_3
    ds_add_rtn_u32 v67, v64, v69 offset:0
K2_RK_3:
    s_mov_b64 exec, -1
    v_lshrrev_b32 v68, 2, v120
    v_mov_b32 v80, 268
    v_lshrrev_b32 v70, 20, v56
    v_lshl_add_u32 v57, v70, 5, v57
    v_and_b32 v56, 0x3fff, v56
    v_lshlrev_b32 v56, 8, v56
    v_lshrrev_b32 v70, 20, v58
    v_lshl_add_u32 v59, v70, 5, v59
    v_and_b32 v58, 0x3fff, v58
    v_lshlrev_b32 v58, 8, v58
    v_lshrrev_b32 v70, 20, v60
    v_lshl_add_u32 v61, v70, 5, v61
    v_and_b32 v60, 0x3fff, v60
    v_lshlrev_b32 v60, 8, v60
    s_waitcnt lgkmcnt(0)
    s_barrier
    ds_read_b32 v69, v68 offset:0
    ds_read_b32 v80, v80
    s_waitcnt lgkmcnt(0)
    v_readfirstlane_b32 s90, v80
    v_add_u32 v70, 3, v69
    v_and_b32 v70, -4, v70
    v_mov_b32 v71, v70
    s_nop 1
    v_add_u32_dpp v71, v71, v71 row_shr:1 row_mask:0xf bank_mask:0xf bound_ctrl:1
    s_nop 1
    v_add_u32_dpp v71, v71, v71 row_shr:2 row_mask:0xf bank_mask:0xf bound_ctrl:1
    s_nop 1
    v_add_u32_dpp v71, v71, v71 row_shr:4 row_mask:0xf bank_mask:0xf bound_ctrl:1
    s_nop 1
    v_add_u32_dpp v71, v71, v71 row_shr:8 row_mask:0xf bank_mask:0xf bound_ctrl:1
    s_nop 1
    v_add_u32_dpp v71, v71, v71 row_bcast:15 row_mask:0xa bank_mask:0xf
    s_nop 1
    v_add_u32_dpp v71, v71, v71 row_bcast:31 row_mask:0xc bank_mask:0xf
    v_sub_u32 v72, v71, v70
    s_nop 0
    v_readlane_b32 s37, v71, 63
    ds_bpermute_b32 v73, v62, v72
    ds_bpermute_b32 v74, v63, v72
    ds_bpermute_b32 v75, v64, v72
    v_lshlrev_b32 v62, 7, v62
    v_lshlrev_b32 v63, 7, v63
    v_lshlrev_b32 v64, 7, v64
    s_waitcnt lgkmcnt(2)
    s_mov_b64 exec, s[46:47]
    s_cbranch_execz K2_PL_4
    v_add_u32 v73, v73, v65
    v_and_b32 v65, 3, v65
    v_lshlrev_b32 v76, 2, v73
    v_cmp_eq_u32 vcc, 0, v65
    ds_write_b32 v76, v56 offset:512
    ds_write_b32 v76, v57 offset:13568
    s_and_b64 exec, exec, vcc
    s_cbranch_execz K2_PL_4
    ds_write_b32 v76, v62 offset:7048
    s_cmp_eq_u32 s90, 0
    s_cbranch_scc1 K2_PL_4
    v_and_b32 v77, 0xffffffc0, v76
    v_bfe_u32 v65, v76, 5, 1
    v_lshl_add_u32 v77, v65, 4, v77
    v_bfe_u32 v65, v76, 4, 1
    v_lshl_add_u32 v77, v65, 2, v77
    ds_write_b32 v77, v62 offset:7072
K2_PL_4:
    s_mov_b64 exec, -1
    s_waitcnt lgkmcnt(0)
    s_mov_b64 exec, s[48:49]
    s_cbranch_execz K2_PL_5
    v_add_u32 v74, v74, v66
    v_and_b32 v66, 3, v66
    v_lshlrev_b32 v76, 2, v74
    v_cmp_eq_u32 vcc, 0, v66
    ds_write_b32 v76, v58 offset:512
    ds_write_b32 v76, v59 offset:13568
    s_and_b64 exec, exec, vcc
    s_cbranch_execz K2_PL_5
    ds_write_b32 v76, v63 offset:7048
    s_cmp_eq_u32 s90, 0
    s_cbranch_scc1 K2_PL_5
    v_and_b32 v77, 0xffffffc0, v76
    v_bfe_u32 v66, v76, 5, 1
    v_lshl_add_u32 v77, v66, 4, v77
    v_bfe_u32 v66, v76, 4, 1
    v_lshl_add_u32 v77, v66, 2, v77
    ds_write_b32 v77, v63 offset:7072
K2_PL_5:
    s_mov_b64 exec, -1
    s_mov_b64 exec, s[50:51]
    s_cbranch_execz K2_PL_6
    v_add_u32 v75, v75, v67
    v_and_b32 v67, 3, v67
    v_lshlrev_b32 v76, 2, v75
    v_cmp_eq_u32 vcc, 0, v67
    ds_write_b32 v76, v60 offset:512
    ds_write_b32 v76, v61 offset:13568
    s_and_b64 exec, exec, vcc
    s_cbranch_execz K2_PL_6
    ds_write_b32 v76, v64 offset:7048
    s_cmp_eq_u32 s90, 0
    s_cbranch_scc1 K2_PL_6
    v_and_b32 v77, 0xffffffc0, v76
    v_bfe_u32 v67, v76, 5, 1
    v_lshl_add_u32 v77, v67, 4, v77
    v_bfe_u32 v67, v76, 4, 1
    v_lshl_add_u32 v77, v67, 2, v77
    ds_write_b32 v77, v64 offset:7072
K2_PL_6:
    s_mov_b64 exec, -1
    s_add_u32 s56, s37, 15
    s_lshr_b32 s57, s56, 4
    s_cmp_ge_u32 s28, 2
    s_cbranch_scc1 K2_NOTAIL
    v_mov_b32 v78, 2560000
    v_mov_b32 v79, 0
    s_cmp_eq_u32 s28, 0
    s_cbranch_scc0 K2_NOPAD
    v_mov_b32 v76, s57
    v_mov_b32 v77, 264
    ds_write_b32 v77, v76
    v_add_u32 v76, v72, v69
    v_cmp_lt_u32 vcc, v76, v71
    s_and_b64 exec, exec, vcc
    s_cbranch_execz K2_NOTAIL
    v_lshlrev_b32 v77, 2, v76
    ds_write_b32 v77, v78 offset:512
    ds_write_b32 v77, v79 offset:13568
    v_add_u32 v76, 1, v76
    v_cmp_lt_u32 vcc, v76, v71
    s_and_b64 exec, exec, vcc
    s_cbranch_execz K2_NOTAIL
    v_lshlrev_b32 v77, 2, v76
    ds_write_b32 v77, v78 offset:512
    ds_write_b32 v77, v79 offset:13568
    v_add_u32 v76, 1, v76
    v_cmp_lt_u32 vcc, v76, v71
    s_and_b64 exec, exec, vcc
    s_cbranch_execz K2_NOTAIL
    v_lshlrev_b32 v77, 2, v76
    ds_write_b32 v77, v78 offset:512
    ds_write_b32 v77, v79 offset:13568
    v_add_u32 v76, 1, v76
    s_branch K2_NOTAIL
K2_NOPAD:
    v_lshrrev_b32 v76, 4, v120
    v_add_u32 v76, s37, v76
    s_lshl_b32 s58, s57, 4
    v_cmp_gt_u32 vcc, s58, v76
    s_and_b64 exec, exec, vcc
    s_cbranch_execz K2_NOTAIL
    v_lshlrev_b32 v77, 2, v76
    ds_write_b32 v77, v78 offset:512
    ds_write_b32 v77, v79 offset:13568
    v_and_b32 v76, 3, v76
    v_cmp_eq_u32 vcc, 0, v76
    s_and_b64 exec, exec, vcc
    s_cbranch_execz K2_NOTAIL
    ds_write_b32 v77, v79 offset:7048
    v_and_b32 v76, 0xffffffc0, v77
    v_bfe_u32 v78, v77, 5, 1
    v_lshl_add_u32 v76, v78, 4, v76
    v_bfe_u32 v78, v77, 4, 1
    v_lshl_add_u32 v76, v78, 2, v76
    ds_write_b32 v76, v79 offset:7072
K2_NOTAIL:
    s_mov_b64 exec, -1
    s_waitcnt lgkmcnt(0)
    s_barrier
    s_branch K2_JOIN
K2_G:
    v_subrev_u32 v100, 0x2000, v8
    v_mov_b32 v121, v9
    v_mov_b32 v103, v10
    s_sub_u32 s62, s28, 8
    s_mul_i32 s57, s29, 10240
    s_add_u32 s58, s57, 8192
    s_mov_b32 s59, 6881280
    s_mov_b32 s60, 6889472
    s_lshl_b32 s61, s62, 12
    s_add_u32 s61, s61, 6815744
    v_lshrrev_b32 v101, 8, v100
    v_mul_u32_u24 v101, 272, v101
    v_lshl_add_u32 v101, v121, 4, v101
    v_add_u32 v101, 90752, v101
    v_cmp_gt_u32 vcc, 0x1000, v100
    s_waitcnt lgkmcnt(0)
    s_mov_b32 s12, s4
    s_and_b32 s13, s5, 0xffff
    s_mov_b32 s14, 2560000
    s_mov_b32 s15, 0x00020000
    buffer_load_dwordx4 v[56:59], v100, s[12:15], s57 offen
    buffer_load_dwordx4 v[60:63], v100, s[12:15], s58 offen
    s_mov_b32 s24, s10
    s_and_b32 s25, s11, 0xffff
    s_mov_b32 s26, 18874368
    s_mov_b32 s27, 0x00020000
    buffer_load_dwordx4 v[64:67], v100, s[24:27], s59 offen
    buffer_load_dwordx4 v[68:71], v120, s[24:27], s60 offen
    s_barrier
    s_mov_b32 s16, s6
    s_and_b32 s17, s7, 0xffff
    s_mov_b32 s18, 10240000
    s_mov_b32 s19, 0x00020000
    s_mov_b32 s20, s8
    s_and_b32 s21, s9, 0xffff
    s_mov_b32 s22, 2560000
    s_mov_b32 s23, 0x00020000
    s_waitcnt vmcnt(3)
    ds_write_b128 v101, v[56:59]
    s_and_saveexec_b64 s[54:55], vcc
    s_waitcnt vmcnt(2)
    ds_write_b128 v101, v[60:63] offset:8704
    s_mov_b64 exec, -1
    s_waitcnt vmcnt(1)
    ds_write_b128 v100, v[64:67] offset:40576
    s_waitcnt vmcnt(0)
    s_cmp_eq_u32 s62, 0
    s_cbranch_scc0 K2_NOA
    ds_write_b128 v120, v[68:71] offset:48768
K2_NOA:
    v_mul_u32_u24 v101, 272, v121
    v_lshl_add_u32 v101, v103, 4, v101
    v_add_u32 v101, 90752, v101
    s_waitcnt lgkmcnt(0)
    s_barrier
    buffer_load_dwordx4 v[8:11], v120, s[24:27], s61 offen offset:0
    buffer_load_dwordx4 v[12:15], v120, s[24:27], s61 offen offset:1024
    buffer_load_dwordx4 v[16:19], v120, s[24:27], s61 offen offset:2048
    buffer_load_dwordx4 v[20:23], v120, s[24:27], s61 offen offset:3072
    s_add_u32 s61, s61, 32768
    buffer_load_dwordx4 v[24:27], v120, s[24:27], s61 offen offset:0
    buffer_load_dwordx4 v[28:31], v120, s[24:27], s61 offen offset:1024
    buffer_load_dwordx4 v[32:35], v120, s[24:27], s61 offen offset:2048
    buffer_load_dwordx4 v[36:39], v120, s[24:27], s61 offen offset:3072
    ds_read_b128 v[40:43], v101 offset:0
    ds_read_b128 v[44:47], v101 offset:64
    ds_read_b128 v[48:51], v101 offset:128
    ds_read_b128 v[52:55], v101 offset:192
    ds_read_b128 v[68:71], v101 offset:4352
    ds_read_b128 v[72:75], v101 offset:4416
    ds_read_b128 v[76:79], v101 offset:4480
    ds_read_b128 v[80:83], v101 offset:4544
    ds_read_b128 v[84:87], v101 offset:8704
    ds_read_b128 v[88:91], v101 offset:8768
    ds_read_b128 v[92:95], v101 offset:8832
    ds_read_b128 v[96:99], v101 offset:8896
    v_lshlrev_b32 v102, 11, v103
    v_lshl_add_u32 v102, v121, 2, v102
    s_lshl_b32 s56, s62, 6
    v_add_u32 v102, s56, v102
    v_mov_b32 v122, 256
    s_mov_b32 s56, 0xbfb8aa3b
    s_mov_b32 s57, 0x42265af6
    v_lshlrev_b32 v101, 1, v102
    v_add_u32 v101, 49792, v101
    s_and_b32 s58, s62, 3
    s_lshl_b32 s58, s58, 1
    s_lshr_b32 s59, 0x72, s58
    s_and_b32 s59, s59, 3
    s_lshl_b32 s59, s59, 2
    s_lshr_b32 s58, s62, 2
    s_lshl_b32 s58, s58, 8
    s_add_u32 s59, s58, s59
    v_lshlrev_b32 v127, 11, v103
    v_lshl_add_u32 v127, v121, 4, v127
    v_add_u32 v127, s59, v127
    s_barrier
    ds_read_b32 v122, v122
    s_waitcnt vmcnt(0)
    s_waitcnt lgkmcnt(1)
    v_mfma_f32_16x16x32_bf16 v[56:59], v[40:43], v[8:11], 0
    v_mfma_f32_16x16x32_bf16 v[56:59], v[44:47], v[12:15], v[56:59]
    v_mfma_f32_16x16x32_bf16 v[56:59], v[48:51], v[16:19], v[56:59]
    v_mfma_f32_16x16x32_bf16 v[56:59], v[52:55], v[20:23], v[56:59]
    v_mfma_f32_16x16x32_bf16 v[60:63], v[68:71], v[8:11], 0
    v_mfma_f32_16x16x32_bf16 v[60:63], v[72:75], v[12:15], v[60:63]
    v_mfma_f32_16x16x32_bf16 v[60:63], v[76:79], v[16:19], v[60:63]
    v_mfma_f32_16x16x32_bf16 v[60:63], v[80:83], v[20:23], v[60:63]
    v_mfma_f32_16x16x32_bf16 v[64:67], v[84:87], v[8:11], 0
    v_mfma_f32_16x16x32_bf16 v[64:67], v[88:91], v[12:15], v[64:67]
    v_mfma_f32_16x16x32_bf16 v[64:67], v[92:95], v[16:19], v[64:67]
    v_mfma_f32_16x16x32_bf16 v[64:67], v[96:99], v[20:23], v[64:67]
    v_mfma_f32_16x16x32_bf16 v[104:107], v[40:43], v[24:27], 0
    v_mfma_f32_16x16x32_bf16 v[104:107], v[44:47], v[28:31], v[104:107]
    v_mfma_f32_16x16x32_bf16 v[104:107], v[48:51], v[32:35], v[104:107]
    v_mfma_f32_16x16x32_bf16 v[104:107], v[52:55], v[36:39], v[104:107]
    v_mfma_f32_16x16x32_bf16 v[108:111], v[68:71], v[24:27], 0
    v_mfma_f32_16x16x32_bf16 v[108:111], v[72:75], v[28:31], v[108:111]
    v_mfma_f32_16x16x32_bf16 v[108:111], v[76:79], v[32:35], v[108:111]
    v_mfma_f32_16x16x32_bf16 v[108:111], v[80:83], v[36:39], v[108:111]
    v_mfma_f32_16x16x32_bf16 v[112:115], v[84:87], v[24:27], 0
    v_mfma_f32_16x16x32_bf16 v[112:115], v[88:91], v[28:31], v[112:115]
    v_mfma_f32_16x16x32_bf16 v[112:115], v[92:95], v[32:35], v[112:115]
    v_mfma_f32_16x16x32_bf16 v[112:115], v[96:99], v[36:39], v[112:115]
    s_waitcnt lgkmcnt(0)
    v_readfirstlane_b32 s43, v122
    v_max3_f32 v122, |v56|, |v57|, |v58|
    v_max3_f32 v122, |v59|, |v60|, v122
    v_max3_f32 v122, |v61|, |v62|, v122
    v_max3_f32 v122, |v63|, |v64|, v122
    v_max3_f32 v122, |v65|, |v66|, v122
    v_max_f32_e64 v122, |v67|, v122
    v_mov_b32 v100, 268
    v_cmp_nge_f32 vcc, s57, v122
    v_mov_b32 v123, 1
    s_and_saveexec_b64 s[54:55], vcc
    s_cbranch_execz K2_NOFLAG
    ds_write_b32 v100, v123
K2_NOFLAG:
    s_mov_b64 exec, -1
    v_cvt_f64_f32 v[40:41], v104
    v_cvt_f64_f32 v[42:43], v105
    v_cvt_f64_f32 v[44:45], v106
    v_cvt_f64_f32 v[46:47], v107
    ds_write_b64 v101, v[40:41] offset:0
    ds_write_b64 v101, v[42:43] offset:1024
    ds_write_b64 v101, v[44:45] offset:2048
    ds_write_b64 v101, v[46:47] offset:3072
    v_cvt_f64_f32 v[68:69], v108
    v_cvt_f64_f32 v[70:71], v109
    v_cvt_f64_f32 v[72:73], v110
    v_cvt_f64_f32 v[74:75], v111
    ds_write_b64 v101, v[68:69] offset:16384
    ds_write_b64 v101, v[70:71] offset:17408
    ds_write_b64 v101, v[72:73] offset:18432
    ds_write_b64 v101, v[74:75] offset:19456
    s_mov_b64 exec, s[30:31]
    v_cvt_f64_f32 v[84:85], v112
    v_cvt_f64_f32 v[86:87], v113
    v_cvt_f64_f32 v[88:89], v114
    v_cvt_f64_f32 v[90:91], v115
    ds_write_b64 v101, v[84:85] offset:32768
    ds_write_b64 v101, v[86:87] offset:33792
    ds_write_b64 v101, v[88:89] offset:34816
    ds_write_b64 v101, v[90:91] offset:35840
    s_mov_b64 exec, -1
    v_mov_b32 v123, 0xc1d00000
    s_waitcnt lgkmcnt(0)
    s_barrier
    ds_read_b32 v100, v100
    s_waitcnt lgkmcnt(0)
    v_readfirstlane_b32 s58, v100
    s_nop 3
    s_cmp_lg_u32 s58, 0
    s_cbranch_scc1 K2_PADD
    v_fma_f32 v56, v56, s56, v123
    v_fma_f32 v57, v57, s56, v123
    v_fma_f32 v58, v58, s56, v123
    v_fma_f32 v59, v59, s56, v123
    v_fma_f32 v60, v60, s56, v123
    v_fma_f32 v61, v61, s56, v123
    v_fma_f32 v62, v62, s56, v123
    v_fma_f32 v63, v63, s56, v123
    v_fma_f32 v64, v64, s56, v123
    v_fma_f32 v65, v65, s56, v123
    v_fma_f32 v66, v66, s56, v123
    v_fma_f32 v67, v67, s56, v123
    v_exp_f32 v56, v56
    v_exp_f32 v57, v57
    v_exp_f32 v58, v58
    v_exp_f32 v59, v59
    v_exp_f32 v60, v60
    v_exp_f32 v61, v61
    v_exp_f32 v62, v62
    v_exp_f32 v63, v63
    v_exp_f32 v64, v64
    v_exp_f32 v65, v65
    v_exp_f32 v66, v66
    v_exp_f32 v67, v67
    ds_write_b32 v127, v56 offset:20096
    ds_write_b32 v127, v57 offset:20608
    ds_write_b32 v127, v58 offset:21120
    ds_write_b32 v127, v59 offset:21632
    ds_write_b32 v127, v60 offset:28288
    ds_write_b32 v127, v61 offset:28800
    ds_write_b32 v127, v62 offset:29312
    ds_write_b32 v127, v63 offset:29824
    s_mov_b64 exec, s[30:31]
    ds_write_b32 v127, v64 offset:36480
    ds_write_b32 v127, v65 offset:36992
    ds_write_b32 v127, v66 offset:37504
    ds_write_b32 v127, v67 offset:38016
    s_branch K2_PDONE
K2_PADD:
    v_mul_f32 v56, s56, v56
    v_mul_f32 v57, s56, v57
    v_mul_f32 v58, s56, v58
    v_mul_f32 v59, s56, v59
    v_mul_f32 v60, s56, v60
    v_mul_f32 v61, s56, v61
    v_mul_f32 v62, s56, v62
    v_mul_f32 v63, s56, v63
    v_mul_f32 v64, s56, v64
    v_mul_f32 v65, s56, v65
    v_mul_f32 v66, s56, v66
    v_mul_f32 v67, s56, v67
    v_cvt_pk_bf16_f32 v56, v56, 0
    v_cvt_pk_bf16_f32 v57, v57, 0
    v_cvt_pk_bf16_f32 v58, v58, 0
    v_cvt_pk_bf16_f32 v59, v59, 0
    v_cvt_pk_bf16_f32 v60, v60, 0
    v_cvt_pk_bf16_f32 v61, v61, 0
    v_cvt_pk_bf16_f32 v62, v62, 0
    v_cvt_pk_bf16_f32 v63, v63, 0
    v_cvt_pk_bf16_f32 v64, v64, 0
    v_cvt_pk_bf16_f32 v65, v65, 0
    v_cvt_pk_bf16_f32 v66, v66, 0
    v_cvt_pk_bf16_f32 v67, v67, 0
    ds_write_b32 v102, v56 offset:20096
    ds_write_b32 v102, v57 offset:20608
    ds_write_b32 v102, v58 offset:21120
    ds_write_b32 v102, v59 offset:21632
    ds_write_b32 v102, v60 offset:28288
    ds_write_b32 v102, v61 offset:28800
    ds_write_b32 v102, v62 offset:29312
    ds_write_b32 v102, v63 offset:29824
    s_mov_b64 exec, s[30:31]
    ds_write_b32 v102, v64 offset:36480
    ds_write_b32 v102, v65 offset:36992
    ds_write_b32 v102, v66 offset:37504
    ds_write_b32 v102, v67 offset:38016
K2_PDONE:
    s_mov_b64 exec, -1
    s_waitcnt lgkmcnt(0)
    s_barrier
    s_branch K2_JOIN
K2_G_WINDOW:
    s_barrier
    s_barrier
    s_barrier
K2_JOIN:
    s_cmp_eq_u32 s28, 0
    s_cbranch_scc0 K2_NOZ2
    v_lshrrev_b32 v68, 2, v120
    v_mov_b32 v69, 0
    ds_write_b32 v68, v69 offset:0
    s_waitcnt lgkmcnt(0)
K2_NOZ2:
    v_mov_b32 v70, 264
    ds_read_b64 v[70:71], v70
    ds_read_b128 v[72:75], v120 offset:40576
    ds_read_b128 v[76:79], v120 offset:41600
    ds_read_b128 v[80:83], v120 offset:42624
    ds_read_b128 v[84:87], v120 offset:43648
    ds_read_b128 v[88:91], v120 offset:48768
    v_lshrrev_b32 v117, 2, v116
    v_mov_b32 v6, v116
    s_waitcnt lgkmcnt(5)
    v_readfirstlane_b32 s57, v70
    v_readfirstlane_b32 s90, v71
    s_lshr_b32 s58, s57, 4
    s_and_b32 s59, s57, 15
    s_cmp_lt_u32 s28, s59
    s_cselect_b32 s38, 1, 0
    s_add_u32 s38, s38, s58
    s_mul_i32 s58, s58, s28
    s_min_u32 s59, s59, s28
    s_add_u32 s58, s58, s59
    s_lshl_b32 s37, s38, 1
    s_cmp_eq_u32 s38, 0
    s_cbranch_scc1 K2_LOOP_DONE
    s_setprio 3
    s_lshl_b32 s60, s58, 4
    v_add_lshl_u32 v122, v4, s60, 2
    s_lshl_b32 s62, s58, 9
    s_add_u32 s62, s62, 103808
    v_add_u32 v119, s62, v2
    s_lshl_b32 s60, s58, 6
    v_add_u32 v118, s60, v3
    s_mov_b32 s45, 0
    s_mov_b32 s36, 0
    s_mov_b32 s39, 0
    s_mov_b32 s40, 0
    s_mov_b32 s41, 0
    s_mov_b32 s92, 64
    s_mov_b32 s93, 512
    s_sub_i32 s91, s38, 3
    s_sub_u32 s89, s37, 2
    ds_read_b32 v123, v122 offset:13568
    v_add_u32 v122, 64, v122
    v_mov_b32 v114, v118
    v_mov_b32 v115, v119
    s_waitcnt lgkmcnt(0)
    s_mov_b32 m0, s62
    v_add_u32 v123, v123, v5
    s_add_u32 s62, s62, 512
    s_add_u32 s45, s45, 1
    s_mov_b64 exec, s[30:31]
    buffer_load_dwordx4 v123, s[16:19], s63 offen sc0 sc1 lds
    s_mov_b64 exec, -1
    s_cmp_lt_u32 s45, s38
    s_cbranch_scc0 K2_ND1
    ds_read_b32 v123, v122 offset:13568
    v_add_u32 v122, 64, v122
    s_waitcnt lgkmcnt(0)
    s_mov_b32 m0, s62
    v_add_u32 v123, v123, v5
    s_add_u32 s62, s62, 512
    s_add_u32 s45, s45, 1
    s_mov_b64 exec, s[30:31]
    buffer_load_dwordx4 v123, s[16:19], s63 offen sc0 sc1 lds
    s_mov_b64 exec, -1
    ds_read_b32 v123, v122 offset:13568
    v_add_u32 v122, 64, v122
K2_ND1:
    s_cmp_lg_u32 s90, 0
    s_cbranch_scc1 K2_SETUP_ADD
    v_mov_b32 v88, 0
    v_mov_b32 v89, 0
    v_mov_b32 v90, 0
    v_mov_b32 v91, 0
    ds_read_b128 v[104:107], v114 offset:512
    ds_read_b32 v110, v114 offset:7048
    v_add_u32 v114, 64, v114
    s_waitcnt lgkmcnt(0)
    v_pk_add_f32 v[104:105], v[104:105], v[116:117] op_sel_hi:[1,0]
    v_pk_add_f32 v[106:107], v[106:107], v[116:117] op_sel_hi:[1,0]
    buffer_load_dwordx4 v[8:11], v104, s[24:27], s41 offen
    buffer_load_dwordx4 v[12:15], v105, s[24:27], s41 offen
    buffer_load_dwordx4 v[16:19], v106, s[24:27], s41 offen
    buffer_load_dwordx4 v[20:23], v107, s[24:27], s41 offen
    s_cmp_lt_u32 s45, s38
    s_cbranch_scc1 K2_ND_7
K2_NDB_8:
    s_add_u32 s39, s39, 1
    s_cmp_eq_u32 s39, s38
    s_cbranch_scc1 K2_LW_9
K2_LWB_10:
    v_mov_b32 v126, v110
    ds_read_b128 v[104:107], v114 offset:512
    ds_read_b32 v110, v114 offset:7048
    v_add_u32 v114, 64, v114
    s_waitcnt lgkmcnt(0)
    v_pk_add_f32 v[104:105], v[104:105], v[116:117] op_sel_hi:[1,0]
    v_pk_add_f32 v[106:107], v[106:107], v[116:117] op_sel_hi:[1,0]
    buffer_load_dwordx4 v[24:27], v104, s[24:27], s41 offen
    buffer_load_dwordx4 v[28:31], v105, s[24:27], s41 offen
    buffer_load_dwordx4 v[32:35], v106, s[24:27], s41 offen
    buffer_load_dwordx4 v[36:39], v107, s[24:27], s41 offen
    s_cmp_lt_u32 s45, s38
    s_cbranch_scc1 K2_ND_11
K2_NDB_12:
    s_add_u32 s39, s39, 1
    s_cmp_eq_u32 s39, s38
    s_cbranch_scc1 K2_LW_13
K2_LWB_14:
    s_waitcnt vmcnt(8)
    s_cmp_eq_u32 s40, s38
    s_cbranch_scc1 K2_AW_15
K2_AWB_16:
    s_add_u32 s40, s40, 1
    v_add_lshl_u32 v111, v126, v117, 1
    v_add_u32 v1, v126, v6
    s_mov_b64 exec, s[30:31]
    ds_read_b128 v[88:91], v115
    s_mov_b64 exec, -1
    ds_read_b128 v[124:127], v1 offset:20096
    v_add_u32 v115, 512, v115
    s_waitcnt lgkmcnt(0)
K2_LOOPF:
    s_cmp_lt_i32 s36, s91
    s_cbranch_scc1 K2_W_17
    s_waitcnt vmcnt(4)
K2_W_17:
    s_waitcnt vmcnt(6)
    v_pk_mov_b32 v[60:61], v[8:9], v[12:13] op_sel:[0,0]
    v_pk_mov_b32 v[62:63], v[16:17], v[20:21] op_sel:[0,0]
    v_pk_mov_b32 v[68:69], v[8:9], v[12:13] op_sel:[1,1]
    v_pk_mov_b32 v[70:71], v[16:17], v[20:21] op_sel:[1,1]
    v_lshlrev_b32 v56, 16, v8
    v_lshlrev_b32 v57, 16, v12
    v_lshlrev_b32 v58, 16, v16
    v_lshlrev_b32 v59, 16, v20
    v_lshlrev_b32 v64, 16, v9
    v_lshlrev_b32 v65, 16, v13
    v_lshlrev_b32 v66, 16, v17
    v_lshlrev_b32 v67, 16, v21
    s_waitcnt lgkmcnt(4)
    v_mfma_f32_16x16x32_bf16 v[60:63], v[88:91], v[76:79], v[60:63]
    v_mfma_f32_16x16x32_bf16 v[68:71], v[88:91], v[84:87], v[68:71]
    v_mfma_f32_16x16x32_bf16 v[56:59], v[88:91], v[72:75], v[56:59]
    v_mfma_f32_16x16x32_bf16 v[64:67], v[88:91], v[80:83], v[64:67]
    s_cmp_eq_u32 s40, s38
    s_cbranch_scc1 K2_AW_18
K2_AWB_19:
    s_add_u32 s40, s40, 1
    v_add_lshl_u32 v112, v110, v117, 1
    v_add_u32 v1, v110, v6
    s_mov_b64 exec, s[30:31]
    ds_read_b128 v[88:91], v115
    s_mov_b64 exec, -1
    ds_read_b128 v[104:107], v114 offset:512
    ds_read_b32 v110, v114 offset:7048
    v_pk_add_f32 v[114:115], v[114:115], s[92:93]
    v_exp_f32 v92, v60
    v_exp_f32 v93, v68
    v_exp_f32 v94, v61
    v_exp_f32 v95, v69
    v_exp_f32 v96, v62
    v_exp_f32 v97, v70
    v_exp_f32 v98, v63
    v_exp_f32 v99, v71
    s_waitcnt lgkmcnt(3)
    v_pk_fma_f32 v[92:93], v[92:93], v[124:125], s[34:35] clamp
    v_pk_fma_f32 v[94:95], v[94:95], v[124:125], s[34:35] clamp
    v_pk_fma_f32 v[96:97], v[96:97], v[124:125], s[34:35] clamp
    v_pk_fma_f32 v[98:99], v[98:99], v[124:125], s[34:35] clamp
    v_pk_mul_f32 v[100:101], v[10:11], v[94:95]
    v_pk_mul_f32 v[102:103], v[18:19], v[98:99]
    v_pk_fma_f32 v[100:101], v[14:15], v[92:93], v[100:101]
    v_pk_fma_f32 v[102:103], v[22:23], v[96:97], v[102:103]
    v_pk_mul_f32 v[92:93], v[92:93], v[94:95]
    v_pk_mul_f32 v[96:97], v[96:97], v[98:99]
    v_pk_mul_f32 v[94:95], v[92:93], v[96:97]
    v_pk_mul_f32 v[100:101], v[100:101], v[96:97]
    v_rcp_f32 v94, v94
    v_rcp_f32 v95, v95
    v_pk_fma_f32 v[100:101], v[102:103], v[92:93], v[100:101]
    v_pk_mul_f32 v[100:101], v[100:101], v[94:95]
    v_cvt_f64_f32 v[92:93], v100
    v_cvt_f64_f32 v[96:97], v101
    ds_add_f64 v111, v[92:93] offset:49920
    ds_add_f64 v111, v[96:97] offset:50176
    s_waitcnt lgkmcnt(3)
    s_cmp_ge_u32 s36, s89
    s_cbranch_scc1 K2_SG_20
    v_pk_add_f32 v[104:105], v[104:105], v[116:117] op_sel_hi:[1,0]
    v_pk_add_f32 v[106:107], v[106:107], v[116:117] op_sel_hi:[1,0]
    buffer_load_dwordx4 v[40:43], v104, s[24:27], s41 offen
    buffer_load_dwordx4 v[44:47], v105, s[24:27], s41 offen
    buffer_load_dwordx4 v[48:51], v106, s[24:27], s41 offen
    buffer_load_dwordx4 v[52:55], v107, s[24:27], s41 offen
    s_cmp_lt_u32 s45, s38
    s_cbranch_scc1 K2_ND_21
K2_NDB_22:
    s_add_u32 s39, s39, 1
    s_cmp_eq_u32 s39, s38
    s_cbranch_scc1 K2_LW_23
K2_LWB_24:
K2_SG_20:
    v_lshlrev_b32 v10, 16, v10
    v_lshlrev_b32 v11, 16, v11
    v_lshlrev_b32 v14, 16, v14
    v_lshlrev_b32 v15, 16, v15
    v_lshlrev_b32 v18, 16, v18
    v_lshlrev_b32 v19, 16, v19
    v_lshlrev_b32 v22, 16, v22
    v_lshlrev_b32 v23, 16, v23
    v_exp_f32 v92, v56
    v_exp_f32 v93, v64
    v_exp_f32 v94, v57
    v_exp_f32 v95, v65
    v_exp_f32 v96, v58
    v_exp_f32 v97, v66
    v_exp_f32 v98, v59
    v_exp_f32 v99, v67
    v_pk_fma_f32 v[92:93], v[92:93], v[126:127], s[34:35] clamp
    v_pk_fma_f32 v[94:95], v[94:95], v[126:127], s[34:35] clamp
    v_pk_fma_f32 v[96:97], v[96:97], v[126:127], s[34:35] clamp
    v_pk_fma_f32 v[98:99], v[98:99], v[126:127], s[34:35] clamp
    v_pk_mul_f32 v[100:101], v[10:11], v[94:95]
    v_pk_mul_f32 v[102:103], v[18:19], v[98:99]
    v_pk_fma_f32 v[100:101], v[14:15], v[92:93], v[100:101]
    v_pk_fma_f32 v[102:103], v[22:23], v[96:97], v[102:103]
    v_pk_mul_f32 v[92:93], v[92:93], v[94:95]
    v_pk_mul_f32 v[96:97], v[96:97], v[98:99]
    v_pk_mul_f32 v[94:95], v[92:93], v[96:97]
    v_pk_mul_f32 v[100:101], v[100:101], v[96:97]
    v_rcp_f32 v94, v94
    v_rcp_f32 v95, v95
    v_pk_fma_f32 v[100:101], v[102:103], v[92:93], v[100:101]
    v_pk_mul_f32 v[100:101], v[100:101], v[94:95]
    v_cvt_f64_f32 v[92:93], v100
    v_cvt_f64_f32 v[96:97], v101
    ds_add_f64 v111, v[92:93] offset:49792
    ds_add_f64 v111, v[96:97] offset:50048
    ds_read_b128 v[124:127], v1 offset:20096
    s_add_u32 s36, s36, 1
    s_cmp_ge_u32 s36, s89
    s_cbranch_scc1 K2_PR_25
K2_PRB_26:
    s_cmp_lt_i32 s36, s91
    s_cbranch_scc1 K2_W_27
    s_waitcnt vmcnt(4)
K2_W_27:
    s_waitcnt vmcnt(6)
    v_pk_mov_b32 v[60:61], v[24:25], v[28:29] op_sel:[0,0]
    v_pk_mov_b32 v[62:63], v[32:33], v[36:37] op_sel:[0,0]
    v_pk_mov_b32 v[68:69], v[24:25], v[28:29] op_sel:[1,1]
    v_pk_mov_b32 v[70:71], v[32:33], v[36:37] op_sel:[1,1]
    v_lshlrev_b32 v56, 16, v24
    v_lshlrev_b32 v57, 16, v28
    v_lshlrev_b32 v58, 16, v32
    v_lshlrev_b32 v59, 16, v36
    v_lshlrev_b32 v64, 16, v25
    v_lshlrev_b32 v65, 16, v29
    v_lshlrev_b32 v66, 16, v33
    v_lshlrev_b32 v67, 16, v37
    s_waitcnt lgkmcnt(4)
    v_mfma_f32_16x16x32_bf16 v[60:63], v[88:91], v[76:79], v[60:63]
    v_mfma_f32_16x16x32_bf16 v[68:71], v[88:91], v[84:87], v[68:71]
    v_mfma_f32_16x16x32_bf16 v[56:59], v[88:91], v[72:75], v[56:59]
    v_mfma_f32_16x16x32_bf16 v[64:67], v[88:91], v[80:83], v[64:67]
    s_cmp_eq_u32 s40, s38
    s_cbranch_scc1 K2_AW_28
K2_AWB_29:
    s_add_u32 s40, s40, 1
    v_add_lshl_u32 v113, v110, v117, 1
    v_add_u32 v1, v110, v6
    s_mov_b64 exec, s[30:31]
    ds_read_b128 v[88:91], v115
    s_mov_b64 exec, -1
    ds_read_b128 v[104:107], v114 offset:512
    ds_read_b32 v110, v114 offset:7048
    v_pk_add_f32 v[114:115], v[114:115], s[92:93]
    v_exp_f32 v92, v60
    v_exp_f32 v93, v68
    v_exp_f32 v94, v61
    v_exp_f32 v95, v69
    v_exp_f32 v96, v62
    v_exp_f32 v97, v70
    v_exp_f32 v98, v63
    v_exp_f32 v99, v71
    s_waitcnt lgkmcnt(3)
    v_pk_fma_f32 v[92:93], v[92:93], v[124:125], s[34:35] clamp
    v_pk_fma_f32 v[94:95], v[94:95], v[124:125], s[34:35] clamp
    v_pk_fma_f32 v[96:97], v[96:97], v[124:125], s[34:35] clamp
    v_pk_fma_f32 v[98:99], v[98:99], v[124:125], s[34:35] clamp
    v_pk_mul_f32 v[100:101], v[26:27], v[94:95]
    v_pk_mul_f32 v[102:103], v[34:35], v[98:99]
    v_pk_fma_f32 v[100:101], v[30:31], v[92:93], v[100:101]
    v_pk_fma_f32 v[102:103], v[38:39], v[96:97], v[102:103]
    v_pk_mul_f32 v[92:93], v[92:93], v[94:95]
    v_pk_mul_f32 v[96:97], v[96:97], v[98:99]
    v_pk_mul_f32 v[94:95], v[92:93], v[96:97]
    v_pk_mul_f32 v[100:101], v[100:101], v[96:97]
    v_rcp_f32 v94, v94
    v_rcp_f32 v95, v95
    v_pk_fma_f32 v[100:101], v[102:103], v[92:93], v[100:101]
    v_pk_mul_f32 v[100:101], v[100:101], v[94:95]
    v_cvt_f64_f32 v[92:93], v100
    v_cvt_f64_f32 v[96:97], v101
    ds_add_f64 v112, v[92:93] offset:49920
    ds_add_f64 v112, v[96:97] offset:50176
    s_waitcnt lgkmcnt(3)
    s_cmp_ge_u32 s36, s89
    s_cbranch_scc1 K2_SG_30
    v_pk_add_f32 v[104:105], v[104:105], v[116:117] op_sel_hi:[1,0]
    v_pk_add_f32 v[106:107], v[106:107], v[116:117] op_sel_hi:[1,0]
    buffer_load_dwordx4 v[8:11], v104, s[24:27], s41 offen
    buffer_load_dwordx4 v[12:15], v105, s[24:27], s41 offen
    buffer_load_dwordx4 v[16:19], v106, s[24:27], s41 offen
    buffer_load_dwordx4 v[20:23], v107, s[24:27], s41 offen
    s_cmp_lt_u32 s45, s38
    s_cbranch_scc1 K2_ND_31
K2_NDB_32:
    s_add_u32 s39, s39, 1
    s_cmp_eq_u32 s39, s38
    s_cbranch_scc1 K2_LW_33
K2_LWB_34:
K2_SG_30:
    v_lshlrev_b32 v26, 16, v26
    v_lshlrev_b32 v27, 16, v27
    v_lshlrev_b32 v30, 16, v30
    v_lshlrev_b32 v31, 16, v31
    v_lshlrev_b32 v34, 16, v34
    v_lshlrev_b32 v35, 16, v35
    v_lshlrev_b32 v38, 16, v38
    v_lshlrev_b32 v39, 16, v39
    v_exp_f32 v92, v56
    v_exp_f32 v93, v64
    v_exp_f32 v94, v57
    v_exp_f32 v95, v65
    v_exp_f32 v96, v58
    v_exp_f32 v97, v66
    v_exp_f32 v98, v59
    v_exp_f32 v99, v67
    v_pk_fma_f32 v[92:93], v[92:93], v[126:127], s[34:35] clamp
    v_pk_fma_f32 v[94:95], v[94:95], v[126:127], s[34:35] clamp
    v_pk_fma_f32 v[96:97], v[96:97], v[126:127], s[34:35] clamp
    v_pk_fma_f32 v[98:99], v[98:99], v[126:127], s[34:35] clamp
    v_pk_mul_f32 v[100:101], v[26:27], v[94:95]
    v_pk_mul_f32 v[102:103], v[34:35], v[98:99]
    v_pk_fma_f32 v[100:101], v[30:31], v[92:93], v[100:101]
    v_pk_fma_f32 v[102:103], v[38:39], v[96:97], v[102:103]
    v_pk_mul_f32 v[92:93], v[92:93], v[94:95]
    v_pk_mul_f32 v[96:97], v[96:97], v[98:99]
    v_pk_mul_f32 v[94:95], v[92:93], v[96:97]
    v_pk_mul_f32 v[100:101], v[100:101], v[96:97]
    v_rcp_f32 v94, v94
    v_rcp_f32 v95, v95
    v_pk_fma_f32 v[100:101], v[102:103], v[92:93], v[100:101]
    v_pk_mul_f32 v[100:101], v[100:101], v[94:95]
    v_cvt_f64_f32 v[92:93], v100
    v_cvt_f64_f32 v[96:97], v101
    ds_add_f64 v112, v[92:93] offset:49792
    ds_add_f64 v112, v[96:97] offset:50048
    ds_read_b128 v[124:127], v1 offset:20096
    s_add_u32 s36, s36, 1
    s_cmp_ge_u32 s36, s89
    s_cbranch_scc1 K2_PR_35
K2_PRB_36:
    s_cmp_lt_i32 s36, s91
    s_cbranch_scc1 K2_W_37
    s_waitcnt vmcnt(4)
K2_W_37:
    s_waitcnt vmcnt(6)
    v_pk_mov_b32 v[60:61], v[40:41], v[44:45] op_sel:[0,0]
    v_pk_mov_b32 v[62:63], v[48:49], v[52:53] op_sel:[0,0]
    v_pk_mov_b32 v[68:69], v[40:41], v[44:45] op_sel:[1,1]
    v_pk_mov_b32 v[70:71], v[48:49], v[52:53] op_sel:[1,1]
    v_lshlrev_b32 v56, 16, v40
    v_lshlrev_b32 v57, 16, v44
    v_lshlrev_b32 v58, 16, v48
    v_lshlrev_b32 v59, 16, v52
    v_lshlrev_b32 v64, 16, v41
    v_lshlrev_b32 v65, 16, v45
    v_lshlrev_b32 v66, 16, v49
    v_lshlrev_b32 v67, 16, v53
    s_waitcnt lgkmcnt(4)
    v_mfma_f32_16x16x32_bf16 v[60:63], v[88:91], v[76:79], v[60:63]
    v_mfma_f32_16x16x32_bf16 v[68:71], v[88:91], v[84:87], v[68:71]
    v_mfma_f32_16x16x32_bf16 v[56:59], v[88:91], v[72:75], v[56:59]
    v_mfma_f32_16x16x32_bf16 v[64:67], v[88:91], v[80:83], v[64:67]
    s_cmp_eq_u32 s40, s38
    s_cbranch_scc1 K2_AW_38
K2_AWB_39:
    s_add_u32 s40, s40, 1
    v_add_lshl_u32 v111, v110, v117, 1
    v_add_u32 v1, v110, v6
    s_mov_b64 exec, s[30:31]
    ds_read_b128 v[88:91], v115
    s_mov_b64 exec, -1
    ds_read_b128 v[104:107], v114 offset:512
    ds_read_b32 v110, v114 offset:7048
    v_pk_add_f32 v[114:115], v[114:115], s[92:93]
    v_exp_f32 v92, v60
    v_exp_f32 v93, v68
    v_exp_f32 v94, v61
    v_exp_f32 v95, v69
    v_exp_f32 v96, v62
    v_exp_f32 v97, v70
    v_exp_f32 v98, v63
    v_exp_f32 v99, v71
    s_waitcnt lgkmcnt(3)
    v_pk_fma_f32 v[92:93], v[92:93], v[124:125], s[34:35] clamp
    v_pk_fma_f32 v[94:95], v[94:95], v[124:125], s[34:35] clamp
    v_pk_fma_f32 v[96:97], v[96:97], v[124:125], s[34:35] clamp
    v_pk_fma_f32 v[98:99], v[98:99], v[124:125], s[34:35] clamp
    v_pk_mul_f32 v[100:101], v[42:43], v[94:95]
    v_pk_mul_f32 v[102:103], v[50:51], v[98:99]
    v_pk_fma_f32 v[100:101], v[46:47], v[92:93], v[100:101]
    v_pk_fma_f32 v[102:103], v[54:55], v[96:97], v[102:103]
    v_pk_mul_f32 v[92:93], v[92:93], v[94:95]
    v_pk_mul_f32 v[96:97], v[96:97], v[98:99]
    v_pk_mul_f32 v[94:95], v[92:93], v[96:97]
    v_pk_mul_f32 v[100:101], v[100:101], v[96:97]
    v_rcp_f32 v94, v94
    v_rcp_f32 v95, v95
    v_pk_fma_f32 v[100:101], v[102:103], v[92:93], v[100:101]
    v_pk_mul_f32 v[100:101], v[100:101], v[94:95]
    v_cvt_f64_f32 v[92:93], v100
    v_cvt_f64_f32 v[96:97], v101
    ds_add_f64 v113, v[92:93] offset:49920
    ds_add_f64 v113, v[96:97] offset:50176
    s_waitcnt lgkmcnt(3)
    s_cmp_ge_u32 s36, s89
    s_cbranch_scc1 K2_SG_40
    v_pk_add_f32 v[104:105], v[104:105], v[116:117] op_sel_hi:[1,0]
    v_pk_add_f32 v[106:107], v[106:107], v[116:117] op_sel_hi:[1,0]
    buffer_load_dwordx4 v[24:27], v104, s[24:27], s41 offen
    buffer_load_dwordx4 v[28:31], v105, s[24:27], s41 offen
    buffer_load_dwordx4 v[32:35], v106, s[24:27], s41 offen
    buffer_load_dwordx4 v[36:39], v107, s[24:27], s41 offen
    s_cmp_lt_u32 s45, s38
    s_cbranch_scc1 K2_ND_41
K2_NDB_42:
    s_add_u32 s39, s39, 1
    s_cmp_eq_u32 s39, s38
    s_cbranch_scc1 K2_LW_43
K2_LWB_44:
K2_SG_40:
    v_lshlrev_b32 v42, 16, v42
    v_lshlrev_b32 v43, 16, v43
    v_lshlrev_b32 v46, 16, v46
    v_lshlrev_b32 v47, 16, v47
    v_lshlrev_b32 v50, 16, v50
    v_lshlrev_b32 v51, 16, v51
    v_lshlrev_b32 v54, 16, v54
    v_lshlrev_b32 v55, 16, v55
    v_exp_f32 v92, v56
    v_exp_f32 v93, v64
    v_exp_f32 v94, v57
    v_exp_f32 v95, v65
    v_exp_f32 v96, v58
    v_exp_f32 v97, v66
    v_exp_f32 v98, v59
    v_exp_f32 v99, v67
    v_pk_fma_f32 v[92:93], v[92:93], v[126:127], s[34:35] clamp
    v_pk_fma_f32 v[94:95], v[94:95], v[126:127], s[34:35] clamp
    v_pk_fma_f32 v[96:97], v[96:97], v[126:127], s[34:35] clamp
    v_pk_fma_f32 v[98:99], v[98:99], v[126:127], s[34:35] clamp
    v_pk_mul_f32 v[100:101], v[42:43], v[94:95]
    v_pk_mul_f32 v[102:103], v[50:51], v[98:99]
    v_pk_fma_f32 v[100:101], v[46:47], v[92:93], v[100:101]
    v_pk_fma_f32 v[102:103], v[54:55], v[96:97], v[102:103]
    v_pk_mul_f32 v[92:93], v[92:93], v[94:95]
    v_pk_mul_f32 v[96:97], v[96:97], v[98:99]
    v_pk_mul_f32 v[94:95], v[92:93], v[96:97]
    v_pk_mul_f32 v[100:101], v[100:101], v[96:97]
    v_rcp_f32 v94, v94
    v_rcp_f32 v95, v95
    v_pk_fma_f32 v[100:101], v[102:103], v[92:93], v[100:101]
    v_pk_mul_f32 v[100:101], v[100:101], v[94:95]
    v_cvt_f64_f32 v[92:93], v100
    v_cvt_f64_f32 v[96:97], v101
    ds_add_f64 v113, v[92:93] offset:49792
    ds_add_f64 v113, v[96:97] offset:50048
    ds_read_b128 v[124:127], v1 offset:20096
    s_add_u32 s36, s36, 1
    s_cmp_ge_u32 s36, s89
    s_cbranch_scc1 K2_PR_45
K2_PRB_46:
    s_branch K2_LOOPF
K2_ND_7:
    s_mov_b32 m0, s62
    v_add_u32 v123, v123, v5
    s_add_u32 s62, s62, 512
    s_add_u32 s45, s45, 1
    s_mov_b64 exec, s[30:31]
    buffer_load_dwordx4 v123, s[16:19], s63 offen sc0 sc1 lds
    s_mov_b64 exec, -1
    ds_read_b32 v123, v122 offset:13568
    v_add_u32 v122, 64, v122
    s_branch K2_NDB_8
K2_LW_9:
    s_mov_b32 s39, 0
    s_mov_b32 s41, 2560256
    v_mov_b32 v114, v118
    s_branch K2_LWB_10
K2_ND_11:
    s_mov_b32 m0, s62
    v_add_u32 v123, v123, v5
    s_add_u32 s62, s62, 512
    s_add_u32 s45, s45, 1
    s_mov_b64 exec, s[30:31]
    buffer_load_dwordx4 v123, s[16:19], s63 offen sc0 sc1 lds
    s_mov_b64 exec, -1
    ds_read_b32 v123, v122 offset:13568
    v_add_u32 v122, 64, v122
    s_branch K2_NDB_12
K2_LW_13:
    s_mov_b32 s39, 0
    s_mov_b32 s41, 2560256
    v_mov_b32 v114, v118
    s_branch K2_LWB_14
K2_AW_15:
    s_mov_b32 s40, 0
    s_cmp_lt_u32 s36, s38
    s_cbranch_scc0 K2_NP_47
    s_setprio 2
K2_NP_47:
    v_add_u32 v117, 256, v117
    v_add_u32 v6, 256, v6
    v_mov_b32 v115, v119
    ds_read_b128 v[72:75], v120 offset:44672
    ds_read_b128 v[76:79], v120 offset:45696
    ds_read_b128 v[80:83], v120 offset:46720
    ds_read_b128 v[84:87], v120 offset:47744
    s_branch K2_AWB_16
K2_AW_18:
    s_mov_b32 s40, 0
    s_cmp_lt_u32 s36, s38
    s_cbranch_scc0 K2_NP_48
    s_setprio 2
K2_NP_48:
    v_add_u32 v117, 256, v117
    v_add_u32 v6, 256, v6
    v_mov_b32 v115, v119
    ds_read_b128 v[72:75], v120 offset:44672
    ds_read_b128 v[76:79], v120 offset:45696
    ds_read_b128 v[80:83], v120 offset:46720
    ds_read_b128 v[84:87], v120 offset:47744
    s_branch K2_AWB_19
K2_ND_21:
    s_mov_b32 m0, s62
    v_add_u32 v123, v123, v5
    s_add_u32 s62, s62, 512
    s_add_u32 s45, s45, 1
    s_mov_b64 exec, s[30:31]
    buffer_load_dwordx4 v123, s[16:19], s63 offen sc0 sc1 lds
    s_mov_b64 exec, -1
    ds_read_b32 v123, v122 offset:13568
    v_add_u32 v122, 64, v122
    s_branch K2_NDB_22
K2_LW_23:
    s_mov_b32 s39, 0
    s_mov_b32 s41, 2560256
    v_mov_b32 v114, v118
    s_branch K2_LWB_24
K2_PR_25:
    s_cmp_ge_u32 s36, s37
    s_cbranch_scc1 K2_LOOP_DONE
    s_cmp_eq_u32 s36, s89
    s_cbranch_scc0 K2_PR1_49
    s_setprio 1
    s_branch K2_PRB_26
K2_PR1_49:
    s_setprio 0
    s_waitcnt vmcnt(0)
    s_branch K2_PRB_26
K2_AW_28:
    s_mov_b32 s40, 0
    s_cmp_lt_u32 s36, s38
    s_cbranch_scc0 K2_NP_50
    s_setprio 2
K2_NP_50:
    v_add_u32 v117, 256, v117
    v_add_u32 v6, 256, v6
    v_mov_b32 v115, v119
    ds_read_b128 v[72:75], v120 offset:44672
    ds_read_b128 v[76:79], v120 offset:45696
    ds_read_b128 v[80:83], v120 offset:46720
    ds_read_b128 v[84:87], v120 offset:47744
    s_branch K2_AWB_29
K2_ND_31:
    s_mov_b32 m0, s62
    v_add_u32 v123, v123, v5
    s_add_u32 s62, s62, 512
    s_add_u32 s45, s45, 1
    s_mov_b64 exec, s[30:31]
    buffer_load_dwordx4 v123, s[16:19], s63 offen sc0 sc1 lds
    s_mov_b64 exec, -1
    ds_read_b32 v123, v122 offset:13568
    v_add_u32 v122, 64, v122
    s_branch K2_NDB_32
K2_LW_33:
    s_mov_b32 s39, 0
    s_mov_b32 s41, 2560256
    v_mov_b32 v114, v118
    s_branch K2_LWB_34
K2_PR_35:
    s_cmp_ge_u32 s36, s37
    s_cbranch_scc1 K2_LOOP_DONE
    s_cmp_eq_u32 s36, s89
    s_cbranch_scc0 K2_PR1_51
    s_setprio 1
    s_branch K2_PRB_36
K2_PR1_51:
    s_setprio 0
    s_waitcnt vmcnt(0)
    s_branch K2_PRB_36
K2_AW_38:
    s_mov_b32 s40, 0
    s_cmp_lt_u32 s36, s38
    s_cbranch_scc0 K2_NP_52
    s_setprio 2
K2_NP_52:
    v_add_u32 v117, 256, v117
    v_add_u32 v6, 256, v6
    v_mov_b32 v115, v119
    ds_read_b128 v[72:75], v120 offset:44672
    ds_read_b128 v[76:79], v120 offset:45696
    ds_read_b128 v[80:83], v120 offset:46720
    ds_read_b128 v[84:87], v120 offset:47744
    s_branch K2_AWB_39
K2_ND_41:
    s_mov_b32 m0, s62
    v_add_u32 v123, v123, v5
    s_add_u32 s62, s62, 512
    s_add_u32 s45, s45, 1
    s_mov_b64 exec, s[30:31]
    buffer_load_dwordx4 v123, s[16:19], s63 offen sc0 sc1 lds
    s_mov_b64 exec, -1
    ds_read_b32 v123, v122 offset:13568
    v_add_u32 v122, 64, v122
    s_branch K2_NDB_42
K2_LW_43:
    s_mov_b32 s39, 0
    s_mov_b32 s41, 2560256
    v_mov_b32 v114, v118
    s_branch K2_LWB_44
K2_PR_45:
    s_cmp_ge_u32 s36, s37
    s_cbranch_scc1 K2_LOOP_DONE
    s_cmp_eq_u32 s36, s89
    s_cbranch_scc0 K2_PR1_53
    s_setprio 1
    s_branch K2_PRB_46
K2_PR1_53:
    s_setprio 0
    s_waitcnt vmcnt(0)
    s_branch K2_PRB_46
K2_SETUP_ADD:
    ds_read_b128 v[104:107], v114 offset:512
    ds_read_b96 v[108:110], v114 offset:7040
    v_add_u32 v114, 64, v114
    s_waitcnt lgkmcnt(0)
    v_pk_add_f32 v[104:105], v[104:105], v[116:117] op_sel_hi:[1,0]
    v_pk_add_f32 v[106:107], v[106:107], v[116:117] op_sel_hi:[1,0]
    buffer_load_dwordx4 v[8:11], v104, s[24:27], s41 offen
    buffer_load_dwordx4 v[12:15], v105, s[24:27], s41 offen
    buffer_load_dwordx4 v[16:19], v106, s[24:27], s41 offen
    buffer_load_dwordx4 v[20:23], v107, s[24:27], s41 offen
    s_cmp_lt_u32 s45, s38
    s_cbranch_scc1 K2_ND_54
K2_NDB_55:
    s_add_u32 s39, s39, 1
    s_cmp_eq_u32 s39, s38
    s_cbranch_scc1 K2_LW_56
K2_LWB_57:
    v_mov_b32 v124, v108
    v_mov_b32 v125, v109
    v_mov_b32 v126, v110
    ds_read_b128 v[104:107], v114 offset:512
    ds_read_b96 v[108:110], v114 offset:7040
    v_add_u32 v114, 64, v114
    s_waitcnt lgkmcnt(0)
    v_pk_add_f32 v[104:105], v[104:105], v[116:117] op_sel_hi:[1,0]
    v_pk_add_f32 v[106:107], v[106:107], v[116:117] op_sel_hi:[1,0]
    buffer_load_dwordx4 v[24:27], v104, s[24:27], s41 offen
    buffer_load_dwordx4 v[28:31], v105, s[24:27], s41 offen
    buffer_load_dwordx4 v[32:35], v106, s[24:27], s41 offen
    buffer_load_dwordx4 v[36:39], v107, s[24:27], s41 offen
    s_cmp_lt_u32 s45, s38
    s_cbranch_scc1 K2_ND_58
K2_NDB_59:
    s_add_u32 s39, s39, 1
    s_cmp_eq_u32 s39, s38
    s_cbranch_scc1 K2_LW_60
K2_LWB_61:
    s_waitcnt vmcnt(8)
    s_cmp_eq_u32 s40, s38
    s_cbranch_scc1 K2_AW_62
K2_AWB_63:
    s_add_u32 s40, s40, 1
    v_pk_add_f32 v[124:125], v[124:125], v[116:117] op_sel:[0,1] op_sel_hi:[1,1]
    v_add_lshl_u32 v111, v126, v117, 1
    s_mov_b64 exec, s[30:31]
    ds_read_b128 v[88:91], v115
    s_mov_b64 exec, s[32:33]
    ds_read_b32 v72, v124 offset:20096
    ds_read_b32 v73, v125 offset:20096
    ds_read_b32 v76, v124 offset:20160
    ds_read_b32 v77, v125 offset:20160
    ds_read_b32 v80, v124 offset:20224
    ds_read_b32 v81, v125 offset:20224
    ds_read_b32 v84, v124 offset:20288
    ds_read_b32 v85, v125 offset:20288
    s_mov_b64 exec, -1
    v_add_u32 v115, 512, v115
    s_waitcnt lgkmcnt(0)
K2_LOOPA:
    s_cmp_lt_i32 s36, s91
    s_cbranch_scc1 K2_W_64
    s_waitcnt vmcnt(4)
K2_W_64:
    s_waitcnt vmcnt(6)
    v_pk_mov_b32 v[60:61], v[8:9], v[12:13] op_sel:[0,0]
    v_pk_mov_b32 v[62:63], v[16:17], v[20:21] op_sel:[0,0]
    v_pk_mov_b32 v[68:69], v[8:9], v[12:13] op_sel:[1,1]
    v_pk_mov_b32 v[70:71], v[16:17], v[20:21] op_sel:[1,1]
    v_lshlrev_b32 v56, 16, v8
    v_lshlrev_b32 v57, 16, v12
    v_lshlrev_b32 v58, 16, v16
    v_lshlrev_b32 v59, 16, v20
    v_lshlrev_b32 v64, 16, v9
    v_lshlrev_b32 v65, 16, v13
    v_lshlrev_b32 v66, 16, v17
    v_lshlrev_b32 v67, 16, v21
    s_waitcnt lgkmcnt(4)
    v_mfma_f32_16x16x32_bf16 v[60:63], v[88:91], v[76:79], v[60:63]
    v_mfma_f32_16x16x32_bf16 v[68:71], v[88:91], v[84:87], v[68:71]
    v_mfma_f32_16x16x32_bf16 v[56:59], v[88:91], v[72:75], v[56:59]
    v_mfma_f32_16x16x32_bf16 v[64:67], v[88:91], v[80:83], v[64:67]
    s_cmp_eq_u32 s40, s38
    s_cbranch_scc1 K2_AW_65
K2_AWB_66:
    s_add_u32 s40, s40, 1
    v_pk_add_f32 v[108:109], v[108:109], v[116:117] op_sel:[0,1] op_sel_hi:[1,1]
    v_add_lshl_u32 v112, v110, v117, 1
    s_mov_b64 exec, s[30:31]
    ds_read_b128 v[88:91], v115
    s_mov_b64 exec, s[32:33]
    ds_read_b32 v72, v108 offset:20096
    ds_read_b32 v73, v109 offset:20096
    ds_read_b32 v76, v108 offset:20160
    ds_read_b32 v77, v109 offset:20160
    ds_read_b32 v80, v108 offset:20224
    ds_read_b32 v81, v109 offset:20224
    ds_read_b32 v84, v108 offset:20288
    ds_read_b32 v85, v109 offset:20288
    s_mov_b64 exec, -1
    ds_read_b128 v[104:107], v114 offset:512
    ds_read_b96 v[108:110], v114 offset:7040
    v_pk_add_f32 v[114:115], v[114:115], s[92:93]
    v_exp_f32_e64 v92, v60 clamp
    v_exp_f32_e64 v93, v68 clamp
    v_exp_f32_e64 v94, v61 clamp
    v_exp_f32_e64 v95, v69 clamp
    v_exp_f32_e64 v96, v62 clamp
    v_exp_f32_e64 v97, v70 clamp
    v_exp_f32_e64 v98, v63 clamp
    v_exp_f32_e64 v99, v71 clamp
    v_pk_add_f32 v[92:93], v[92:93], s[34:35]
    v_pk_add_f32 v[94:95], v[94:95], s[34:35]
    v_pk_add_f32 v[96:97], v[96:97], s[34:35]
    v_pk_add_f32 v[98:99], v[98:99], s[34:35]
    v_pk_mul_f32 v[100:101], v[10:11], v[94:95]
    v_pk_mul_f32 v[102:103], v[18:19], v[98:99]
    v_pk_fma_f32 v[100:101], v[14:15], v[92:93], v[100:101]
    v_pk_fma_f32 v[102:103], v[22:23], v[96:97], v[102:103]
    v_pk_mul_f32 v[92:93], v[92:93], v[94:95]
    v_pk_mul_f32 v[96:97], v[96:97], v[98:99]
    v_pk_mul_f32 v[94:95], v[92:93], v[96:97]
    v_pk_mul_f32 v[100:101], v[100:101], v[96:97]
    v_rcp_f32 v94, v94
    v_rcp_f32 v95, v95
    v_pk_fma_f32 v[100:101], v[102:103], v[92:93], v[100:101]
    v_pk_mul_f32 v[100:101], v[100:101], v[94:95]
    v_cvt_f64_f32 v[92:93], v100
    v_cvt_f64_f32 v[96:97], v101
    ds_add_f64 v111, v[92:93] offset:49920
    ds_add_f64 v111, v[96:97] offset:50176
    s_waitcnt lgkmcnt(3)
    s_cmp_ge_u32 s36, s89
    s_cbranch_scc1 K2_SG_67
    v_pk_add_f32 v[104:105], v[104:105], v[116:117] op_sel_hi:[1,0]
    v_pk_add_f32 v[106:107], v[106:107], v[116:117] op_sel_hi:[1,0]
    buffer_load_dwordx4 v[40:43], v104, s[24:27], s41 offen
    buffer_load_dwordx4 v[44:47], v105, s[24:27], s41 offen
    buffer_load_dwordx4 v[48:51], v106, s[24:27], s41 offen
    buffer_load_dwordx4 v[52:55], v107, s[24:27], s41 offen
    s_cmp_lt_u32 s45, s38
    s_cbranch_scc1 K2_ND_68
K2_NDB_69:
    s_add_u32 s39, s39, 1
    s_cmp_eq_u32 s39, s38
    s_cbranch_scc1 K2_LW_70
K2_LWB_71:
K2_SG_67:
    v_lshlrev_b32 v10, 16, v10
    v_lshlrev_b32 v11, 16, v11
    v_lshlrev_b32 v14, 16, v14
    v_lshlrev_b32 v15, 16, v15
    v_lshlrev_b32 v18, 16, v18
    v_lshlrev_b32 v19, 16, v19
    v_lshlrev_b32 v22, 16, v22
    v_lshlrev_b32 v23, 16, v23
    v_exp_f32_e64 v92, v56 clamp
    v_exp_f32_e64 v93, v64 clamp
    v_exp_f32_e64 v94, v57 clamp
    v_exp_f32_e64 v95, v65 clamp
    v_exp_f32_e64 v96, v58 clamp
    v_exp_f32_e64 v97, v66 clamp
    v_exp_f32_e64 v98, v59 clamp
    v_exp_f32_e64 v99, v67 clamp
    v_pk_add_f32 v[92:93], v[92:93], s[34:35]
    v_pk_add_f32 v[94:95], v[94:95], s[34:35]
    v_pk_add_f32 v[96:97], v[96:97], s[34:35]
    v_pk_add_f32 v[98:99], v[98:99], s[34:35]
    v_pk_mul_f32 v[100:101], v[10:11], v[94:95]
    v_pk_mul_f32 v[102:103], v[18:19], v[98:99]
    v_pk_fma_f32 v[100:101], v[14:15], v[92:93], v[100:101]
    v_pk_fma_f32 v[102:103], v[22:23], v[96:97], v[102:103]
    v_pk_mul_f32 v[92:93], v[92:93], v[94:95]
    v_pk_mul_f32 v[96:97], v[96:97], v[98:99]
    v_pk_mul_f32 v[94:95], v[92:93], v[96:97]
    v_pk_mul_f32 v[100:101], v[100:101], v[96:97]
    v_rcp_f32 v94, v94
    v_rcp_f32 v95, v95
    v_pk_fma_f32 v[100:101], v[102:103], v[92:93], v[100:101]
    v_pk_mul_f32 v[100:101], v[100:101], v[94:95]
    v_cvt_f64_f32 v[92:93], v100
    v_cvt_f64_f32 v[96:97], v101
    ds_add_f64 v111, v[92:93] offset:49792
    ds_add_f64 v111, v[96:97] offset:50048
    s_add_u32 s36, s36, 1
    s_cmp_ge_u32 s36, s89
    s_cbranch_scc1 K2_PR_72
K2_PRB_73:
    s_cmp_lt_i32 s36, s91
    s_cbranch_scc1 K2_W_74
    s_waitcnt vmcnt(4)
K2_W_74:
    s_waitcnt vmcnt(6)
    v_pk_mov_b32 v[60:61], v[24:25], v[28:29] op_sel:[0,0]
    v_pk_mov_b32 v[62:63], v[32:33], v[36:37] op_sel:[0,0]
    v_pk_mov_b32 v[68:69], v[24:25], v[28:29] op_sel:[1,1]
    v_pk_mov_b32 v[70:71], v[32:33], v[36:37] op_sel:[1,1]
    v_lshlrev_b32 v56, 16, v24
    v_lshlrev_b32 v57, 16, v28
    v_lshlrev_b32 v58, 16, v32
    v_lshlrev_b32 v59, 16, v36
    v_lshlrev_b32 v64, 16, v25
    v_lshlrev_b32 v65, 16, v29
    v_lshlrev_b32 v66, 16, v33
    v_lshlrev_b32 v67, 16, v37
    s_waitcnt lgkmcnt(4)
    v_mfma_f32_16x16x32_bf16 v[60:63], v[88:91], v[76:79], v[60:63]
    v_mfma_f32_16x16x32_bf16 v[68:71], v[88:91], v[84:87], v[68:71]
    v_mfma_f32_16x16x32_bf16 v[56:59], v[88:91], v[72:75], v[56:59]
    v_mfma_f32_16x16x32_bf16 v[64:67], v[88:91], v[80:83], v[64:67]
    s_cmp_eq_u32 s40, s38
    s_cbranch_scc1 K2_AW_75
K2_AWB_76:
    s_add_u32 s40, s40, 1
    v_pk_add_f32 v[108:109], v[108:109], v[116:117] op_sel:[0,1] op_sel_hi:[1,1]
    v_add_lshl_u32 v113, v110, v117, 1
    s_mov_b64 exec, s[30:31]
    ds_read_b128 v[88:91], v115
    s_mov_b64 exec, s[32:33]
    ds_read_b32 v72, v108 offset:20096
    ds_read_b32 v73, v109 offset:20096
    ds_read_b32 v76, v108 offset:20160
    ds_read_b32 v77, v109 offset:20160
    ds_read_b32 v80, v108 offset:20224
    ds_read_b32 v81, v109 offset:20224
    ds_read_b32 v84, v108 offset:20288
    ds_read_b32 v85, v109 offset:20288
    s_mov_b64 exec, -1
    ds_read_b128 v[104:107], v114 offset:512
    ds_read_b96 v[108:110], v114 offset:7040
    v_pk_add_f32 v[114:115], v[114:115], s[92:93]
    v_exp_f32_e64 v92, v60 clamp
    v_exp_f32_e64 v93, v68 clamp
    v_exp_f32_e64 v94, v61 clamp
    v_exp_f32_e64 v95, v69 clamp
    v_exp_f32_e64 v96, v62 clamp
    v_exp_f32_e64 v97, v70 clamp
    v_exp_f32_e64 v98, v63 clamp
    v_exp_f32_e64 v99, v71 clamp
    v_pk_add_f32 v[92:93], v[92:93], s[34:35]
    v_pk_add_f32 v[94:95], v[94:95], s[34:35]
    v_pk_add_f32 v[96:97], v[96:97], s[34:35]
    v_pk_add_f32 v[98:99], v[98:99], s[34:35]
    v_pk_mul_f32 v[100:101], v[26:27], v[94:95]
    v_pk_mul_f32 v[102:103], v[34:35], v[98:99]
    v_pk_fma_f32 v[100:101], v[30:31], v[92:93], v[100:101]
    v_pk_fma_f32 v[102:103], v[38:39], v[96:97], v[102:103]
    v_pk_mul_f32 v[92:93], v[92:93], v[94:95]
    v_pk_mul_f32 v[96:97], v[96:97], v[98:99]
    v_pk_mul_f32 v[94:95], v[92:93], v[96:97]
    v_pk_mul_f32 v[100:101], v[100:101], v[96:97]
    v_rcp_f32 v94, v94
    v_rcp_f32 v95, v95
    v_pk_fma_f32 v[100:101], v[102:103], v[92:93], v[100:101]
    v_pk_mul_f32 v[100:101], v[100:101], v[94:95]
    v_cvt_f64_f32 v[92:93], v100
    v_cvt_f64_f32 v[96:97], v101
    ds_add_f64 v112, v[92:93] offset:49920
    ds_add_f64 v112, v[96:97] offset:50176
    s_waitcnt lgkmcnt(3)
    s_cmp_ge_u32 s36, s89
    s_cbranch_scc1 K2_SG_77
    v_pk_add_f32 v[104:105], v[104:105], v[116:117] op_sel_hi:[1,0]
    v_pk_add_f32 v[106:107], v[106:107], v[116:117] op_sel_hi:[1,0]
    buffer_load_dwordx4 v[8:11], v104, s[24:27], s41 offen
    buffer_load_dwordx4 v[12:15], v105, s[24:27], s41 offen
    buffer_load_dwordx4 v[16:19], v106, s[24:27], s41 offen
    buffer_load_dwordx4 v[20:23], v107, s[24:27], s41 offen
    s_cmp_lt_u32 s45, s38
    s_cbranch_scc1 K2_ND_78
K2_NDB_79:
    s_add_u32 s39, s39, 1
    s_cmp_eq_u32 s39, s38
    s_cbranch_scc1 K2_LW_80
K2_LWB_81:
K2_SG_77:
    v_lshlrev_b32 v26, 16, v26
    v_lshlrev_b32 v27, 16, v27
    v_lshlrev_b32 v30, 16, v30
    v_lshlrev_b32 v31, 16, v31
    v_lshlrev_b32 v34, 16, v34
    v_lshlrev_b32 v35, 16, v35
    v_lshlrev_b32 v38, 16, v38
    v_lshlrev_b32 v39, 16, v39
    v_exp_f32_e64 v92, v56 clamp
    v_exp_f32_e64 v93, v64 clamp
    v_exp_f32_e64 v94, v57 clamp
    v_exp_f32_e64 v95, v65 clamp
    v_exp_f32_e64 v96, v58 clamp
    v_exp_f32_e64 v97, v66 clamp
    v_exp_f32_e64 v98, v59 clamp
    v_exp_f32_e64 v99, v67 clamp
    v_pk_add_f32 v[92:93], v[92:93], s[34:35]
    v_pk_add_f32 v[94:95], v[94:95], s[34:35]
    v_pk_add_f32 v[96:97], v[96:97], s[34:35]
    v_pk_add_f32 v[98:99], v[98:99], s[34:35]
    v_pk_mul_f32 v[100:101], v[26:27], v[94:95]
    v_pk_mul_f32 v[102:103], v[34:35], v[98:99]
    v_pk_fma_f32 v[100:101], v[30:31], v[92:93], v[100:101]
    v_pk_fma_f32 v[102:103], v[38:39], v[96:97], v[102:103]
    v_pk_mul_f32 v[92:93], v[92:93], v[94:95]
    v_pk_mul_f32 v[96:97], v[96:97], v[98:99]
    v_pk_mul_f32 v[94:95], v[92:93], v[96:97]
    v_pk_mul_f32 v[100:101], v[100:101], v[96:97]
    v_rcp_f32 v94, v94
    v_rcp_f32 v95, v95
    v_pk_fma_f32 v[100:101], v[102:103], v[92:93], v[100:101]
    v_pk_mul_f32 v[100:101], v[100:101], v[94:95]
    v_cvt_f64_f32 v[92:93], v100
    v_cvt_f64_f32 v[96:97], v101
    ds_add_f64 v112, v[92:93] offset:49792
    ds_add_f64 v112, v[96:97] offset:50048
    s_add_u32 s36, s36, 1
    s_cmp_ge_u32 s36, s89
    s_cbranch_scc1 K2_PR_82
K2_PRB_83:
    s_cmp_lt_i32 s36, s91
    s_cbranch_scc1 K2_W_84
    s_waitcnt vmcnt(4)
K2_W_84:
    s_waitcnt vmcnt(6)
    v_pk_mov_b32 v[60:61], v[40:41], v[44:45] op_sel:[0,0]
    v_pk_mov_b32 v[62:63], v[48:49], v[52:53] op_sel:[0,0]
    v_pk_mov_b32 v[68:69], v[40:41], v[44:45] op_sel:[1,1]
    v_pk_mov_b32 v[70:71], v[48:49], v[52:53] op_sel:[1,1]
    v_lshlrev_b32 v56, 16, v40
    v_lshlrev_b32 v57, 16, v44
    v_lshlrev_b32 v58, 16, v48
    v_lshlrev_b32 v59, 16, v52
    v_lshlrev_b32 v64, 16, v41
    v_lshlrev_b32 v65, 16, v45
    v_lshlrev_b32 v66, 16, v49
    v_lshlrev_b32 v67, 16, v53
    s_waitcnt lgkmcnt(4)
    v_mfma_f32_16x16x32_bf16 v[60:63], v[88:91], v[76:79], v[60:63]
    v_mfma_f32_16x16x32_bf16 v[68:71], v[88:91], v[84:87], v[68:71]
    v_mfma_f32_16x16x32_bf16 v[56:59], v[88:91], v[72:75], v[56:59]
    v_mfma_f32_16x16x32_bf16 v[64:67], v[88:91], v[80:83], v[64:67]
    s_cmp_eq_u32 s40, s38
    s_cbranch_scc1 K2_AW_85
K2_AWB_86:
    s_add_u32 s40, s40, 1
    v_pk_add_f32 v[108:109], v[108:109], v[116:117] op_sel:[0,1] op_sel_hi:[1,1]
    v_add_lshl_u32 v111, v110, v117, 1
    s_mov_b64 exec, s[30:31]
    ds_read_b128 v[88:91], v115
    s_mov_b64 exec, s[32:33]
    ds_read_b32 v72, v108 offset:20096
    ds_read_b32 v73, v109 offset:20096
    ds_read_b32 v76, v108 offset:20160
    ds_read_b32 v77, v109 offset:20160
    ds_read_b32 v80, v108 offset:20224
    ds_read_b32 v81, v109 offset:20224
    ds_read_b32 v84, v108 offset:20288
    ds_read_b32 v85, v109 offset:20288
    s_mov_b64 exec, -1
    ds_read_b128 v[104:107], v114 offset:512
    ds_read_b96 v[108:110], v114 offset:7040
    v_pk_add_f32 v[114:115], v[114:115], s[92:93]
    v_exp_f32_e64 v92, v60 clamp
    v_exp_f32_e64 v93, v68 clamp
    v_exp_f32_e64 v94, v61 clamp
    v_exp_f32_e64 v95, v69 clamp
    v_exp_f32_e64 v96, v62 clamp
    v_exp_f32_e64 v97, v70 clamp
    v_exp_f32_e64 v98, v63 clamp
    v_exp_f32_e64 v99, v71 clamp
    v_pk_add_f32 v[92:93], v[92:93], s[34:35]
    v_pk_add_f32 v[94:95], v[94:95], s[34:35]
    v_pk_add_f32 v[96:97], v[96:97], s[34:35]
    v_pk_add_f32 v[98:99], v[98:99], s[34:35]
    v_pk_mul_f32 v[100:101], v[42:43], v[94:95]
    v_pk_mul_f32 v[102:103], v[50:51], v[98:99]
    v_pk_fma_f32 v[100:101], v[46:47], v[92:93], v[100:101]
    v_pk_fma_f32 v[102:103], v[54:55], v[96:97], v[102:103]
    v_pk_mul_f32 v[92:93], v[92:93], v[94:95]
    v_pk_mul_f32 v[96:97], v[96:97], v[98:99]
    v_pk_mul_f32 v[94:95], v[92:93], v[96:97]
    v_pk_mul_f32 v[100:101], v[100:101], v[96:97]
    v_rcp_f32 v94, v94
    v_rcp_f32 v95, v95
    v_pk_fma_f32 v[100:101], v[102:103], v[92:93], v[100:101]
    v_pk_mul_f32 v[100:101], v[100:101], v[94:95]
    v_cvt_f64_f32 v[92:93], v100
    v_cvt_f64_f32 v[96:97], v101
    ds_add_f64 v113, v[92:93] offset:49920
    ds_add_f64 v113, v[96:97] offset:50176
    s_waitcnt lgkmcnt(3)
    s_cmp_ge_u32 s36, s89
    s_cbranch_scc1 K2_SG_87
    v_pk_add_f32 v[104:105], v[104:105], v[116:117] op_sel_hi:[1,0]
    v_pk_add_f32 v[106:107], v[106:107], v[116:117] op_sel_hi:[1,0]
    buffer_load_dwordx4 v[24:27], v104, s[24:27], s41 offen
    buffer_load_dwordx4 v[28:31], v105, s[24:27], s41 offen
    buffer_load_dwordx4 v[32:35], v106, s[24:27], s41 offen
    buffer_load_dwordx4 v[36:39], v107, s[24:27], s41 offen
    s_cmp_lt_u32 s45, s38
    s_cbranch_scc1 K2_ND_88
K2_NDB_89:
    s_add_u32 s39, s39, 1
    s_cmp_eq_u32 s39, s38
    s_cbranch_scc1 K2_LW_90
K2_LWB_91:
K2_SG_87:
    v_lshlrev_b32 v42, 16, v42
    v_lshlrev_b32 v43, 16, v43
    v_lshlrev_b32 v46, 16, v46
    v_lshlrev_b32 v47, 16, v47
    v_lshlrev_b32 v50, 16, v50
    v_lshlrev_b32 v51, 16, v51
    v_lshlrev_b32 v54, 16, v54
    v_lshlrev_b32 v55, 16, v55
    v_exp_f32_e64 v92, v56 clamp
    v_exp_f32_e64 v93, v64 clamp
    v_exp_f32_e64 v94, v57 clamp
    v_exp_f32_e64 v95, v65 clamp
    v_exp_f32_e64 v96, v58 clamp
    v_exp_f32_e64 v97, v66 clamp
    v_exp_f32_e64 v98, v59 clamp
    v_exp_f32_e64 v99, v67 clamp
    v_pk_add_f32 v[92:93], v[92:93], s[34:35]
    v_pk_add_f32 v[94:95], v[94:95], s[34:35]
    v_pk_add_f32 v[96:97], v[96:97], s[34:35]
    v_pk_add_f32 v[98:99], v[98:99], s[34:35]
    v_pk_mul_f32 v[100:101], v[42:43], v[94:95]
    v_pk_mul_f32 v[102:103], v[50:51], v[98:99]
    v_pk_fma_f32 v[100:101], v[46:47], v[92:93], v[100:101]
    v_pk_fma_f32 v[102:103], v[54:55], v[96:97], v[102:103]
    v_pk_mul_f32 v[92:93], v[92:93], v[94:95]
    v_pk_mul_f32 v[96:97], v[96:97], v[98:99]
    v_pk_mul_f32 v[94:95], v[92:93], v[96:97]
    v_pk_mul_f32 v[100:101], v[100:101], v[96:97]
    v_rcp_f32 v94, v94
    v_rcp_f32 v95, v95
    v_pk_fma_f32 v[100:101], v[102:103], v[92:93], v[100:101]
    v_pk_mul_f32 v[100:101], v[100:101], v[94:95]
    v_cvt_f64_f32 v[92:93], v100
    v_cvt_f64_f32 v[96:97], v101
    ds_add_f64 v113, v[92:93] offset:49792
    ds_add_f64 v113, v[96:97] offset:50048
    s_add_u32 s36, s36, 1
    s_cmp_ge_u32 s36, s89
    s_cbranch_scc1 K2_PR_92
K2_PRB_93:
    s_branch K2_LOOPA
K2_ND_54:
    s_mov_b32 m0, s62
    v_add_u32 v123, v123, v5
    s_add_u32 s62, s62, 512
    s_add_u32 s45, s45, 1
    s_mov_b64 exec, s[30:31]
    buffer_load_dwordx4 v123, s[16:19], s63 offen sc0 sc1 lds
    s_mov_b64 exec, -1
    ds_read_b32 v123, v122 offset:13568
    v_add_u32 v122, 64, v122
    s_branch K2_NDB_55
K2_LW_56:
    s_mov_b32 s39, 0
    s_mov_b32 s41, 2560256
    v_mov_b32 v114, v118
    s_branch K2_LWB_57
K2_ND_58:
    s_mov_b32 m0, s62
    v_add_u32 v123, v123, v5
    s_add_u32 s62, s62, 512
    s_add_u32 s45, s45, 1
    s_mov_b64 exec, s[30:31]
    buffer_load_dwordx4 v123, s[16:19], s63 offen sc0 sc1 lds
    s_mov_b64 exec, -1
    ds_read_b32 v123, v122 offset:13568
    v_add_u32 v122, 64, v122
    s_branch K2_NDB_59
K2_LW_60:
    s_mov_b32 s39, 0
    s_mov_b32 s41, 2560256
    v_mov_b32 v114, v118
    s_branch K2_LWB_61
K2_AW_62:
    s_mov_b32 s40, 0
    s_cmp_lt_u32 s36, s38
    s_cbranch_scc0 K2_NP_94
    s_setprio 2
K2_NP_94:
    v_add_u32 v117, 256, v117
    v_mov_b32 v115, v119
    ds_read_b128 v[72:75], v120 offset:44672
    ds_read_b128 v[76:79], v120 offset:45696
    ds_read_b128 v[80:83], v120 offset:46720
    ds_read_b128 v[84:87], v120 offset:47744
    s_branch K2_AWB_63
K2_AW_65:
    s_mov_b32 s40, 0
    s_cmp_lt_u32 s36, s38
    s_cbranch_scc0 K2_NP_95
    s_setprio 2
K2_NP_95:
    v_add_u32 v117, 256, v117
    v_mov_b32 v115, v119
    ds_read_b128 v[72:75], v120 offset:44672
    ds_read_b128 v[76:79], v120 offset:45696
    ds_read_b128 v[80:83], v120 offset:46720
    ds_read_b128 v[84:87], v120 offset:47744
    s_branch K2_AWB_66
K2_ND_68:
    s_mov_b32 m0, s62
    v_add_u32 v123, v123, v5
    s_add_u32 s62, s62, 512
    s_add_u32 s45, s45, 1
    s_mov_b64 exec, s[30:31]
    buffer_load_dwordx4 v123, s[16:19], s63 offen sc0 sc1 lds
    s_mov_b64 exec, -1
    ds_read_b32 v123, v122 offset:13568
    v_add_u32 v122, 64, v122
    s_branch K2_NDB_69
K2_LW_70:
    s_mov_b32 s39, 0
    s_mov_b32 s41, 2560256
    v_mov_b32 v114, v118
    s_branch K2_LWB_71
K2_PR_72:
    s_cmp_ge_u32 s36, s37
    s_cbranch_scc1 K2_LOOP_DONE
    s_cmp_eq_u32 s36, s89
    s_cbranch_scc0 K2_PR1_96
    s_setprio 1
    s_branch K2_PRB_73
K2_PR1_96:
    s_setprio 0
    s_waitcnt vmcnt(0)
    s_branch K2_PRB_73
K2_AW_75:
    s_mov_b32 s40, 0
    s_cmp_lt_u32 s36, s38
    s_cbranch_scc0 K2_NP_97
    s_setprio 2
K2_NP_97:
    v_add_u32 v117, 256, v117
    v_mov_b32 v115, v119
    ds_read_b128 v[72:75], v120 offset:44672
    ds_read_b128 v[76:79], v120 offset:45696
    ds_read_b128 v[80:83], v120 offset:46720
    ds_read_b128 v[84:87], v120 offset:47744
    s_branch K2_AWB_76
K2_ND_78:
    s_mov_b32 m0, s62
    v_add_u32 v123, v123, v5
    s_add_u32 s62, s62, 512
    s_add_u32 s45, s45, 1
    s_mov_b64 exec, s[30:31]
    buffer_load_dwordx4 v123, s[16:19], s63 offen sc0 sc1 lds
    s_mov_b64 exec, -1
    ds_read_b32 v123, v122 offset:13568
    v_add_u32 v122, 64, v122
    s_branch K2_NDB_79
K2_LW_80:
    s_mov_b32 s39, 0
    s_mov_b32 s41, 2560256
    v_mov_b32 v114, v118
    s_branch K2_LWB_81
K2_PR_82:
    s_cmp_ge_u32 s36, s37
    s_cbranch_scc1 K2_LOOP_DONE
    s_cmp_eq_u32 s36, s89
    s_cbranch_scc0 K2_PR1_98
    s_setprio 1
    s_branch K2_PRB_83
K2_PR1_98:
    s_setprio 0
    s_waitcnt vmcnt(0)
    s_branch K2_PRB_83
K2_AW_85:
    s_mov_b32 s40, 0
    s_cmp_lt_u32 s36, s38
    s_cbranch_scc0 K2_NP_99
    s_setprio 2
K2_NP_99:
    v_add_u32 v117, 256, v117
    v_mov_b32 v115, v119
    ds_read_b128 v[72:75], v120 offset:44672
    ds_read_b128 v[76:79], v120 offset:45696
    ds_read_b128 v[80:83], v120 offset:46720
    ds_read_b128 v[84:87], v120 offset:47744
    s_branch K2_AWB_86
K2_ND_88:
    s_mov_b32 m0, s62
    v_add_u32 v123, v123, v5
    s_add_u32 s62, s62, 512
    s_add_u32 s45, s45, 1
    s_mov_b64 exec, s[30:31]
    buffer_load_dwordx4 v123, s[16:19], s63 offen sc0 sc1 lds
    s_mov_b64 exec, -1
    ds_read_b32 v123, v122 offset:13568
    v_add_u32 v122, 64, v122
    s_branch K2_NDB_89
K2_LW_90:
    s_mov_b32 s39, 0
    s_mov_b32 s41, 2560256
    v_mov_b32 v114, v118
    s_branch K2_LWB_91
K2_PR_92:
    s_cmp_ge_u32 s36, s37
    s_cbranch_scc1 K2_LOOP_DONE
    s_cmp_eq_u32 s36, s89
    s_cbranch_scc0 K2_PR1_100
    s_setprio 1
    s_branch K2_PRB_93
K2_PR1_100:
    s_setprio 0
    s_waitcnt vmcnt(0)
    s_branch K2_PRB_93
K2_LOOP_DONE:
    s_setprio 0
    s_waitcnt vmcnt(0)
    s_waitcnt lgkmcnt(0)
    s_barrier
    s_add_u32 s44, s44, 1500
    s_cmp_lt_u32 s44, s43
    s_cbranch_scc0 K2_EPI
    s_cmp_ge_u32 s28, 8
    s_cbranch_scc1 K2_G_WINDOW
    v_lshrrev_b32 v12, 1, v0
    v_lshlrev_b32 v13, 10, v12
    s_lshl_b32 s56, s29, 2
    s_add_u32 s56, s56, 6553600
    buffer_load_dword v14, v13, s[24:27], s56 offen
    v_and_b32 v33, 1, v0
    v_mul_u32_u24 v39, 1280, v12
    v_cmp_gt_u32 vcc, 250, v12
    v_mov_b32 v36, v121
    v_mul_u32_u24 v34, 40960, v12
    s_waitcnt vmcnt(0)
    v_lshrrev_b32 v32, 16, v14
    v_and_b32 v14, 0xffff, v14
    v_cndmask_b32 v32, 0, v32, vcc
    v_add_u32 v39, v39, v14
    v_sub_u32 v37, s44, v36
    v_max_i32 v37, 0, v37
    v_lshlrev_b32 v38, 2, v39
    v_lshl_add_u32 v35, v33, 5, v38
    v_lshl_add_u32 v38, v33, 3, v38
    v_lshl_add_u32 v35, v37, 2, v35
    v_lshl_add_u32 v38, v37, 2, v38
    s_mov_b32 s60, 5242880
    buffer_load_dwordx4 v[56:59], v35, s[24:27], s60 offen
    buffer_load_dwordx4 v[60:63], v35, s[24:27], s60 offen offset:16
    buffer_load_dwordx2 v[64:65], v38, s[24:27], s60 offen offset:64
    s_waitcnt vmcnt(0)
    s_branch K2_WINDOW
K2_EPI:
    v_cmp_gt_u32 vcc, 640, v0
    s_and_saveexec_b64 s[54:55], vcc
    s_cbranch_execz K2_EXIT
    v_lshlrev_b32 v1, 6, v0
    ds_read_b128 v[32:35], v1 offset:49792
    ds_read_b128 v[36:39], v1 offset:49808
    ds_read_b128 v[40:43], v1 offset:49824
    ds_read_b128 v[44:47], v1 offset:49840
    s_mov_b32 s56, 0x32800000
    s_mov_b32 s57, 0xbfb8aa3b
    s_waitcnt lgkmcnt(0)
    v_cvt_f32_f64 v8, v[32:33]
    v_cvt_f32_f64 v9, v[34:35]
    v_cvt_f32_f64 v10, v[36:37]
    v_cvt_f32_f64 v11, v[38:39]
    v_cvt_f32_f64 v12, v[40:41]
    v_cvt_f32_f64 v13, v[42:43]
    v_cvt_f32_f64 v14, v[44:45]
    v_cvt_f32_f64 v15, v[46:47]
    s_mov_b32 s58, 0xb2b8aa3b
    s_mov_b32 s59, 0xb2b8aa3b
    s_mov_b32 s57, 0x32800000
    s_mov_b32 s60, 1.0
    s_mov_b32 s61, 1.0
    v_pk_mul_f32 v[16:17], v[8:9], s[58:59]
    v_pk_mul_f32 v[18:19], v[10:11], s[58:59]
    v_pk_mul_f32 v[20:21], v[12:13], s[58:59]
    v_pk_mul_f32 v[22:23], v[14:15], s[58:59]
    v_pk_mul_f32 v[8:9], v[8:9], s[56:57]
    v_pk_mul_f32 v[10:11], v[10:11], s[56:57]
    v_pk_mul_f32 v[12:13], v[12:13], s[56:57]
    v_pk_mul_f32 v[14:15], v[14:15], s[56:57]
    v_exp_f32 v16, v16
    v_exp_f32 v17, v17
    v_exp_f32 v18, v18
    v_exp_f32 v19, v19
    v_exp_f32 v20, v20
    v_exp_f32 v21, v21
    v_exp_f32 v22, v22
    v_exp_f32 v23, v23
    v_pk_add_f32 v[16:17], v[16:17], s[60:61]
    v_pk_add_f32 v[18:19], v[18:19], s[60:61]
    v_pk_add_f32 v[20:21], v[20:21], s[60:61]
    v_pk_add_f32 v[22:23], v[22:23], s[60:61]
    v_rcp_f32 v16, v16
    v_rcp_f32 v17, v17
    v_rcp_f32 v18, v18
    v_rcp_f32 v19, v19
    v_rcp_f32 v20, v20
    v_rcp_f32 v21, v21
    v_rcp_f32 v22, v22
    v_rcp_f32 v23, v23
    s_nop 0
    v_pk_mul_f32 v[8:9], v[8:9], v[16:17]
    v_pk_mul_f32 v[10:11], v[10:11], v[18:19]
    v_pk_mul_f32 v[12:13], v[12:13], v[20:21]
    v_pk_mul_f32 v[14:15], v[14:15], v[22:23]
    v_cvt_pk_bf16_f32 v24, v8, v9
    v_cvt_pk_bf16_f32 v25, v10, v11
    v_cvt_pk_bf16_f32 v26, v12, v13
    v_cvt_pk_bf16_f32 v27, v14, v15
    v_lshlrev_b32 v2, 4, v0
    s_mul_i32 s56, s29, 10240
    buffer_store_dwordx4 v[24:27], v2, s[20:23], s56 offen sc1
K2_EXIT:
    s_endpgm
.section .rodata,"a"
.p2align 6
.amdhsa_kernel egc_prep_kernel
  .amdhsa_next_free_vgpr 112
  .amdhsa_next_free_sgpr 96
  .amdhsa_accum_offset 112
  .amdhsa_group_segment_fixed_size 0
  .amdhsa_kernarg_size 80
  .amdhsa_user_sgpr_count 2
  .amdhsa_user_sgpr_kernarg_segment_ptr 1
  .amdhsa_system_sgpr_workgroup_id_x 1
.end_amdhsa_kernel
.p2align 6
.amdhsa_kernel egc_main_kernel
  .amdhsa_next_free_vgpr 128
  .amdhsa_next_free_sgpr 96
  .amdhsa_accum_offset 128
  .amdhsa_group_segment_fixed_size 0
  .amdhsa_kernarg_size 80
  .amdhsa_user_sgpr_count 2
  .amdhsa_user_sgpr_kernarg_segment_ptr 1
  .amdhsa_system_sgpr_workgroup_id_x 1
  .amdhsa_float_denorm_mode_32 3
.end_amdhsa_kernel
```
